```python
import torch

def _softmax(x, axis=-1):
    return torch.softmax(x, dim=axis)
def _gelu(x):
    return torch.nn.functional.gelu(x, approximate="tanh")
def _silu(x):
    return torch.nn.functional.silu(x)
def _sigmoid(x):
    return torch.sigmoid(x)
def _layernorm(x, axis=-1, eps=1e-5):
    m = x.mean(dim=axis, keepdim=True)
    v = x.var(dim=axis, keepdim=True, unbiased=False)
    return (x - m) / torch.sqrt(v + eps)
def _scatter_add(tgt, idx, src, axis=0):
    return tgt.clone().index_add_(axis, idx, src)
def _segment_sum(src, seg, n):
    out = torch.zeros((n,) + src.shape[1:], dtype=src.dtype)
    return out.index_add_(0, seg, src)
def _pad(x, pw):
    flat = tuple(v for pair in reversed(pw) for v in pair)
    return torch.nn.functional.pad(x, flat)

kernel_name = 'standalone__gqa_block_cached__near_ridge'

def setup_inputs():

    _w = (lambda a: (lambda t: t.to(torch.bfloat16) if t.is_floating_point() else t)(torch.as_tensor(a)))
    B, Sq, D = 16, 96, 448
    Hq, Hkv, Sk, Dh = 16, 8, 512, 256
    assert Hq % Hkv == 0, (Hq, Hkv)
    return {
        "x": _w((lambda *s: torch.randn(*s, dtype=torch.bfloat16) * 0.8)(B, Sq, D)),
        "k_cache": _w((lambda *s: torch.randn(*s, dtype=torch.bfloat16) * 0.8)(B, Hkv, Sk, Dh)),
        "v_cache": _w((lambda *s: torch.randn(*s, dtype=torch.bfloat16) * 0.05)(B, Hkv, Sk, Dh)),
        "wq": _w((lambda *s: torch.randn(*s, dtype=torch.bfloat16) * 0.8)(D, Hq * Dh) * (D ** -0.5)),
        "wo": _w((lambda *s: torch.randn(*s, dtype=torch.bfloat16) * 0.05)(Hq * Dh, D) * ((Hq * Dh) ** -0.5)),
    }

def reference(x, k_cache, v_cache, wq, wo):
    B, Sq, D = x.shape
    Hq, Dh = 16, 256
    Hkv = k_cache.shape[1]
    rep = Hq // Hkv
    q = (lambda x, *d: x.permute(*d))((x @ wq).reshape(B, Sq, Hq, Dh), 0, 2, 1, 3)
    k = (lambda x, n, axis: torch.repeat_interleave(x, n, dim=axis))(k_cache, rep, axis=1)
    v = (lambda x, n, axis: torch.repeat_interleave(x, n, dim=axis))(v_cache, rep, axis=1)
    scores = torch.einsum("bhqd,bhkd->bhqk", q, k) * (Dh ** -0.5)
    p = _softmax(scores, axis=-1)
    o = torch.einsum("bhqk,bhkd->bhqd", p, v)
    return (lambda x, *d: x.permute(*d))(o, 0, 2, 1, 3).reshape(B, Sq, Hq * Dh) @ wo
```

```asm
; @launch kernel=standalone__gqa_block_cached__near_ridge_kernel grid=(256,1,1) block=(256,1,1) lds=163840
; @launch kernel=gqa_reduce_kernel grid=(1344,1,1) block=(64,1,1) lds=0
.amdgcn_target "amdgcn-amd-amdhsa--gfx950"
.text
.globl standalone__gqa_block_cached__near_ridge_kernel
.p2align 8
.type standalone__gqa_block_cached__near_ridge_kernel,@function
standalone__gqa_block_cached__near_ridge_kernel:
    s_cmp_ge_u32 s2, 256
    s_cbranch_scc1 L_k1_end
    s_load_dwordx8 s[40:47], s[0:1], 0
    s_load_dwordx2 s[48:49], s[0:1], 32
    s_load_dwordx2 s[50:51], s[0:1], 56
    v_and_b32 v255, 63, v0
    v_lshrrev_b32 v1, 6, v0
    s_and_b32 s4, s2, 7
    s_lshr_b32 s5, s2, 3
    v_readfirstlane_b32 s3, v1
    s_lshr_b32 s6, s5, 1
    s_and_b32 s7, s5, 1
    s_getpc_b64 s[54:55]
L_pc0:
    s_mul_i32 s38, s5, 1280
    v_lshlrev_b32 v2, 7, v255
    v_add_u32 v2, s38, v2
    v_min_u32 v2, L_code_end-L_pc0-4, v2
    v_cmp_gt_u32 vcc, 10, v255
    s_nop 3
    s_and_saveexec_b64 s[38:39], vcc
    s_cbranch_execz L_pf_skip
    global_load_dword v3, v2, s[54:55]
L_pf_skip:
    s_mov_b64 exec, s[38:39]
    v_lshrrev_b32 v202, 3, v255
    v_lshlrev_b32 v202, 13, v202
    v_and_b32 v199, 7, v255
    v_lshrrev_b32 v198, 4, v255
    v_and_b32 v198, 1, v198
    v_lshlrev_b32 v198, 2, v198
    v_xor_b32 v199, v199, v198
    v_lshlrev_b32 v199, 4, v199
    v_add_u32 v202, v202, v199
    v_add_u32 v203, 64512, v202
    v_add_u32 v205, 129024, v202
    v_add_u32 v206, 193536, v202
    s_and_b32 s38, s3, 1
    s_lshl_b32 s38, s38, 6
    v_lshrrev_b32 v200, 3, v255
    v_mul_u32_u24 v200, 0x380, v200
    v_and_b32 v199, 7, v255
    v_lshrrev_b32 v198, 4, v255
    v_xor_b32 v199, v199, v198
    v_xor_b32 v199, 0, v199
    v_lshlrev_b32 v199, 4, v199
    v_add_u32 v200, v200, v199
    v_xor_b32 v200, s38, v200
    v_lshrrev_b32 v201, 3, v255
    v_add_u32 v201, 8, v201
    v_mul_u32_u24 v201, 0x380, v201
    v_and_b32 v199, 7, v255
    v_lshrrev_b32 v198, 4, v255
    v_xor_b32 v199, v199, v198
    v_xor_b32 v199, 4, v199
    v_lshlrev_b32 v199, 4, v199
    v_add_u32 v201, v201, v199
    v_add_u32 v201, 0xfffffc00, v201
    v_xor_b32 v201, s38, v201
    v_add_u32 v204, 12288, v200
    s_mul_i32 s54, s3, 21504
    s_mul_i32 s55, s3, 3072
    s_mul_i32 s39, s4, 1
    s_add_u32 s39, s39, s6
    s_mul_i32 s38, s7, 0
    s_add_u32 s39, s39, s38
    s_mul_i32 s38, s39, 37
    s_lshr_b32 s38, s38, 8
    s_mul_i32 s38, s38, 7
    s_sub_u32 s34, s39, s38
    s_lshl_b32 s38, s4, 1
    s_add_u32 s7, s7, s38
    s_mul_i32 s32, s3, 28672
    s_add_u32 s32, s32, 49152
    s_mov_b32 s33, 0x3db8aa3b
    s_lshl_b32 s98, s3, 7
    s_waitcnt lgkmcnt(0)
    s_lshl_b32 s38, s7, 9
    s_sub_u32 s39, 3670016, s38
    s_add_u32 s12, s46, s38
    s_addc_u32 s13, s47, 0
    s_and_b32 s13, s13, 0xffff
    s_mov_b32 s14, s39
    s_mov_b32 s15, 0x20000
    s_mul_i32 s38, s6, 86016
    s_add_u32 s8, s40, s38
    s_addc_u32 s9, s41, 0
    s_and_b32 s9, s9, 0xffff
    s_mov_b32 s10, 86016
    s_mov_b32 s11, 0x20000
    s_mov_b32 s99, s34
    s_mov_b32 s100, s34
    s_lshl_b32 s96, s99, 19
    s_add_u32 s96, s96, s98
    s_add_u32 s99, s99, 1
    s_cmp_eq_u32 s99, 7
    s_cselect_b32 s99, 0, s99
    s_lshl_b32 s97, s99, 19
    s_add_u32 s97, s97, s98
    s_add_u32 m0, s55, 0
    s_lshl_b32 s37, s100, 7
    s_add_u32 s37, s37, s54
    buffer_load_dwordx4 v200, s[8:11], s37 offen offset:0  lds
    buffer_load_dwordx4 v201, s[8:11], s37 offen offset:1024  lds
    buffer_load_dwordx4 v204, s[8:11], s37 offen offset:2048  lds
    s_add_u32 s100, s100, 1
    s_cmp_eq_u32 s100, 7
    s_cselect_b32 s100, 0, s100
    s_add_u32 m0, s32, 12288
    s_add_u32 s37, s96, 0
    buffer_load_dwordx4 v202, s[12:15], s37 offen offset:0  lds
    buffer_load_dwordx4 v203, s[12:15], s37 offen offset:1024  lds
    buffer_load_dwordx4 v205, s[12:15], s37 offen offset:2048  lds
    buffer_load_dwordx4 v206, s[12:15], s37 offen offset:3072  lds
    s_add_u32 m0, s32, 16384
    s_add_u32 s37, s96, 262144
    buffer_load_dwordx4 v202, s[12:15], s37 offen offset:0  lds
    buffer_load_dwordx4 v203, s[12:15], s37 offen offset:1024  lds
    buffer_load_dwordx4 v205, s[12:15], s37 offen offset:2048  lds
    buffer_load_dwordx4 v206, s[12:15], s37 offen offset:3072  lds
    s_add_u32 s99, s99, 1
    s_cmp_eq_u32 s99, 7
    s_cselect_b32 s99, 0, s99
    s_lshl_b32 s96, s99, 19
    s_add_u32 s96, s96, s98
    v_and_b32 v210, 31, v255
    v_lshlrev_b32 v210, 7, v210
    v_lshrrev_b32 v199, 5, v255
    v_and_b32 v198, 31, v255
    v_lshrrev_b32 v198, 1, v198
    v_and_b32 v198, 7, v198
    v_xor_b32 v199, v199, v198
    v_lshlrev_b32 v199, 4, v199
    v_add_u32 v210, v210, v199
    v_xor_b32 v213, 32, v210
    v_xor_b32 v250, 64, v210
    v_xor_b32 v251, 96, v210
    v_mov_b32 v207, s32
    v_add_u32 v207, 0x2000, v207
    v_lshrrev_b32 v199, 4, v255
    v_lshrrev_b32 v199, 1, v199
    v_lshlrev_b32 v199, 3, v199
    v_and_b32 v198, 15, v255
    v_lshrrev_b32 v198, 2, v198
    v_add_u32 v199, v199, v198
    v_lshlrev_b32 v199, 7, v199
    v_add_u32 v207, v207, v199
    v_lshrrev_b32 v199, 4, v255
    v_and_b32 v199, 1, v199
    v_lshlrev_b32 v199, 1, v199
    v_and_b32 v198, 15, v255
    v_and_b32 v198, 3, v198
    v_and_b32 v198, 1, v198
    v_add_u32 v199, v199, v198
    v_and_b32 v198, 15, v255
    v_lshrrev_b32 v198, 3, v198
    v_and_b32 v198, 1, v198
    v_lshlrev_b32 v198, 2, v198
    v_xor_b32 v199, v199, v198
    v_lshlrev_b32 v199, 4, v199
    v_add_u32 v207, v207, v199
    v_and_b32 v199, 15, v255
    v_and_b32 v199, 3, v199
    v_lshrrev_b32 v199, 1, v199
    v_lshlrev_b32 v199, 3, v199
    v_add_u32 v207, v207, v199
    v_xor_b32 v208, 64, v207
    s_add_u32 m0, s32, 20480
    s_add_u32 s37, s97, 0
    buffer_load_dwordx4 v202, s[12:15], s37 offen offset:0  lds
    buffer_load_dwordx4 v203, s[12:15], s37 offen offset:1024  lds
    buffer_load_dwordx4 v205, s[12:15], s37 offen offset:2048  lds
    buffer_load_dwordx4 v206, s[12:15], s37 offen offset:3072  lds
    s_lshl_b32 s38, s6, 3
    s_add_u32 s38, s38, s4
    s_lshl_b32 s38, s38, 18
    s_add_u32 s16, s42, s38
    s_addc_u32 s17, s43, 0
    s_and_b32 s17, s17, 0xffff
    s_mov_b32 s18, 262144
    s_mov_b32 s19, 0x20000
    s_add_u32 s20, s44, s38
    s_addc_u32 s21, s45, 0
    s_and_b32 s21, s21, 0xffff
    s_mov_b32 s22, 262144
    s_mov_b32 s23, 0x20000
    s_mul_i32 s38, s7, 229376
    s_add_u32 s24, s48, s38
    s_addc_u32 s25, s49, 0
    s_and_b32 s25, s25, 0xffff
    s_mov_b32 s26, 229376
    s_mov_b32 s27, 0x20000
    s_lshl_b32 s38, s6, 4
    s_add_u32 s38, s38, s7
    s_mul_i32 s38, s38, 86016
    s_add_u32 s28, s50, s38
    s_addc_u32 s29, s51, 0
    s_and_b32 s29, s29, 0xffff
    s_mov_b32 s30, 86016
    s_mov_b32 s31, 0x20000
    v_lshrrev_b32 v214, 3, v255
    v_lshlrev_b32 v214, 9, v214
    v_and_b32 v199, 7, v255
    v_lshrrev_b32 v198, 4, v255
    v_and_b32 v198, 7, v198
    v_xor_b32 v199, v199, v198
    v_lshlrev_b32 v199, 4, v199
    v_add_u32 v214, v214, v199
    v_lshrrev_b32 v215, 3, v255
    v_add_u32 v215, 8, v215
    v_lshlrev_b32 v215, 9, v215
    v_and_b32 v199, 7, v255
    v_lshrrev_b32 v198, 4, v255
    v_add_u32 v198, 4, v198
    v_and_b32 v198, 7, v198
    v_xor_b32 v199, v199, v198
    v_lshlrev_b32 v199, 4, v199
    v_add_u32 v215, v215, v199
    v_add_u32 v215, 0xfffffc00, v215
    v_add_u32 v216, 6144, v214
    v_add_u32 v217, 6144, v215
    v_and_b32 v212, 31, v255
    v_lshlrev_b32 v212, 9, v212
    v_lshrrev_b32 v199, 5, v255
    v_and_b32 v198, 15, v255
    v_xor_b32 v199, v199, v198
    v_lshlrev_b32 v199, 4, v199
    v_add_u32 v212, v212, v199
    v_and_b32 v218, 31, v255
    v_lshlrev_b32 v218, 7, v218
    v_add_u32 v218, s32, v218
    v_lshrrev_b32 v199, 5, v255
    v_and_b32 v198, 31, v255
    v_lshrrev_b32 v198, 1, v198
    v_and_b32 v198, 7, v198
    v_xor_b32 v199, v199, v198
    v_lshlrev_b32 v199, 4, v199
    v_add_u32 v218, v218, v199
    v_and_b32 v219, 31, v255
    v_lshlrev_b32 v219, 7, v219
    v_add_u32 v219, s32, v219
    v_lshrrev_b32 v199, 5, v255
    v_add_u32 v199, 2, v199
    v_and_b32 v198, 31, v255
    v_lshrrev_b32 v198, 1, v198
    v_and_b32 v198, 7, v198
    v_xor_b32 v199, v199, v198
    v_lshlrev_b32 v199, 4, v199
    v_add_u32 v219, v219, v199
    v_and_b32 v220, 31, v255
    v_lshlrev_b32 v220, 7, v220
    v_add_u32 v220, s32, v220
    v_lshrrev_b32 v199, 5, v255
    v_add_u32 v199, 4, v199
    v_and_b32 v198, 31, v255
    v_lshrrev_b32 v198, 1, v198
    v_and_b32 v198, 7, v198
    v_xor_b32 v199, v199, v198
    v_lshlrev_b32 v199, 4, v199
    v_add_u32 v220, v220, v199
    v_and_b32 v221, 31, v255
    v_lshlrev_b32 v221, 7, v221
    v_add_u32 v221, s32, v221
    v_lshrrev_b32 v199, 5, v255
    v_add_u32 v199, 6, v199
    v_and_b32 v198, 31, v255
    v_lshrrev_b32 v198, 1, v198
    v_and_b32 v198, 7, v198
    v_xor_b32 v199, v199, v198
    v_lshlrev_b32 v199, 4, v199
    v_add_u32 v221, v221, v199
    s_add_u32 m0, s55, 12288
    s_lshl_b32 s37, s100, 7
    s_add_u32 s37, s37, s54
    buffer_load_dwordx4 v200, s[8:11], s37 offen offset:0  lds
    buffer_load_dwordx4 v201, s[8:11], s37 offen offset:1024  lds
    buffer_load_dwordx4 v204, s[8:11], s37 offen offset:2048  lds
    s_add_u32 s100, s100, 1
    s_cmp_eq_u32 s100, 7
    s_cselect_b32 s100, 0, s100
    s_add_u32 m0, s32, 24576
    s_add_u32 s37, s97, 262144
    buffer_load_dwordx4 v202, s[12:15], s37 offen offset:0  lds
    buffer_load_dwordx4 v203, s[12:15], s37 offen offset:1024  lds
    buffer_load_dwordx4 v205, s[12:15], s37 offen offset:2048  lds
    buffer_load_dwordx4 v206, s[12:15], s37 offen offset:3072  lds
    s_add_u32 s99, s99, 1
    s_cmp_eq_u32 s99, 7
    s_cselect_b32 s99, 0, s99
    s_lshl_b32 s97, s99, 19
    s_add_u32 s97, s97, s98
    v_lshrrev_b32 v222, 3, v255
    v_lshlrev_b32 v222, 9, v222
    v_and_b32 v199, 7, v255
    v_lshrrev_b32 v198, 4, v255
    v_and_b32 v198, 1, v198
    v_lshlrev_b32 v198, 2, v198
    v_xor_b32 v199, v199, v198
    v_lshlrev_b32 v199, 4, v199
    v_add_u32 v222, v222, v199
    v_add_u32 v223, 3072, v222
    v_add_u32 v253, 6144, v222
    v_add_u32 v254, 9216, v222
    v_lshrrev_b32 v224, 4, v255
    v_lshrrev_b32 v224, 1, v224
    v_lshlrev_b32 v224, 2, v224
    v_and_b32 v199, 15, v255
    v_lshrrev_b32 v199, 2, v199
    v_add_u32 v224, v224, v199
    v_lshlrev_b32 v224, 7, v224
    v_add_u32 v224, s32, v224
    v_lshrrev_b32 v199, 4, v255
    v_and_b32 v199, 1, v199
    v_lshlrev_b32 v199, 1, v199
    v_and_b32 v198, 15, v255
    v_and_b32 v198, 3, v198
    v_lshrrev_b32 v198, 1, v198
    v_add_u32 v199, v199, v198
    v_and_b32 v198, 15, v255
    v_lshrrev_b32 v198, 3, v198
    v_and_b32 v198, 1, v198
    v_lshlrev_b32 v198, 2, v198
    v_xor_b32 v199, v199, v198
    v_lshlrev_b32 v199, 4, v199
    v_add_u32 v224, v224, v199
    v_and_b32 v199, 15, v255
    v_and_b32 v199, 1, v199
    v_lshlrev_b32 v199, 3, v199
    v_add_u32 v224, v224, v199
    v_lshrrev_b32 v225, 4, v255
    v_lshrrev_b32 v225, 1, v225
    v_lshlrev_b32 v225, 2, v225
    v_and_b32 v199, 15, v255
    v_lshrrev_b32 v199, 2, v199
    v_add_u32 v225, v225, v199
    v_lshlrev_b32 v225, 7, v225
    v_add_u32 v225, s32, v225
    v_lshrrev_b32 v199, 4, v255
    v_and_b32 v199, 1, v199
    v_lshlrev_b32 v199, 1, v199
    v_and_b32 v198, 15, v255
    v_and_b32 v198, 3, v198
    v_lshrrev_b32 v198, 1, v198
    v_add_u32 v199, v199, v198
    v_add_u32 v199, 4, v199
    v_and_b32 v198, 15, v255
    v_lshrrev_b32 v198, 3, v198
    v_and_b32 v198, 1, v198
    v_lshlrev_b32 v198, 2, v198
    v_xor_b32 v199, v199, v198
    v_lshlrev_b32 v199, 4, v199
    v_add_u32 v225, v225, v199
    v_and_b32 v199, 15, v255
    v_and_b32 v199, 1, v199
    v_lshlrev_b32 v199, 3, v199
    v_add_u32 v225, v225, v199
    v_and_b32 v228, 31, v255
    v_lshlrev_b32 v228, 8, v228
    v_lshrrev_b32 v199, 5, v255
    v_and_b32 v198, 15, v255
    v_xor_b32 v199, v199, v198
    v_lshlrev_b32 v199, 4, v199
    v_add_u32 v228, v228, v199
    v_xor_b32 v229, 32, v228
    v_xor_b32 v230, 64, v228
    v_xor_b32 v231, 96, v228
    v_xor_b32 v232, 128, v228
    v_xor_b32 v233, 160, v228
    v_xor_b32 v234, 192, v228
    v_xor_b32 v235, 224, v228
    s_lshl_b32 s38, s3, 6
    v_xor_b32 v226, s38, v228
    v_xor_b32 v227, 32, v226
    v_and_b32 v237, 31, v255
    v_lshlrev_b32 v237, 4, v237
    s_lshl_b32 s38, s3, 2
    v_add_u32 v236, s38, v237
    s_lshl_b32 s57, s3, 7
    s_mov_b32 s38, 0
    s_lshl_b32 s56, s3, 14
    s_sub_u32 s52, s56, s38
    s_add_u32 s56, s56, s38
    s_sub_u32 s53, s57, s38
    s_add_u32 s57, s57, s38
    s_lshl_b32 s38, s3, 7
    v_xor_b32 v249, s38, v212
    s_add_u32 m0, s32, 8192
    s_add_u32 s37, s96, 0
    buffer_load_dwordx4 v202, s[12:15], s37 offen offset:0  lds
    buffer_load_dwordx4 v203, s[12:15], s37 offen offset:1024  lds
    buffer_load_dwordx4 v205, s[12:15], s37 offen offset:2048  lds
    buffer_load_dwordx4 v206, s[12:15], s37 offen offset:3072  lds
    s_waitcnt vmcnt(23)
    s_barrier
    ds_read_b128 a[32:35], v210 offset:0
    ds_read_b128 a[36:39], v210 offset:4096
    ds_read_b128 a[40:43], v210 offset:8192
    ds_read_b128 a[44:47], v213 offset:0
    ds_read_b128 a[48:51], v213 offset:4096
    ds_read_b128 a[52:55], v213 offset:8192
    s_waitcnt vmcnt(19)
    ds_read_b64_tr_b16 a[0:1], v207 offset:4096
    ds_read_b64_tr_b16 a[2:3], v207 offset:4608
    ds_read_b64_tr_b16 a[4:5], v208 offset:4096
    ds_read_b64_tr_b16 a[6:7], v208 offset:4608
    ds_read_b64_tr_b16 a[8:9], v207 offset:6144
    ds_read_b64_tr_b16 a[10:11], v207 offset:6656
    ds_read_b64_tr_b16 a[12:13], v208 offset:6144
    ds_read_b64_tr_b16 a[14:15], v208 offset:6656
    s_waitcnt lgkmcnt(6)
    v_mfma_f32_32x32x16_bf16 v[0:15], a[0:3], a[32:35], 0
    s_add_u32 m0, s32, 12288
    s_add_u32 s37, s96, 262144
    s_waitcnt lgkmcnt(0)
    buffer_load_dwordx4 v202, s[12:15], s37 offen offset:0  lds
    ds_read_b128 a[56:59], v250 offset:0
    ds_read_b128 a[60:63], v250 offset:4096
    v_mfma_f32_32x32x16_bf16 v[16:31], a[0:3], a[36:39], 0
    ds_read_b128 a[64:67], v250 offset:8192
    v_mfma_f32_32x32x16_bf16 v[32:47], a[0:3], a[40:43], 0
    buffer_load_dwordx4 v203, s[12:15], s37 offen offset:1024  lds
    ds_read_b128 a[68:71], v251 offset:0
    v_mfma_f32_32x32x16_bf16 v[48:63], a[4:7], a[32:35], 0
    buffer_load_dwordx4 v205, s[12:15], s37 offen offset:2048  lds
    ds_read_b128 a[72:75], v251 offset:4096
    v_mfma_f32_32x32x16_bf16 v[64:79], a[4:7], a[36:39], 0
    ds_read_b128 a[76:79], v251 offset:8192
    v_mfma_f32_32x32x16_bf16 v[80:95], a[4:7], a[40:43], 0
    buffer_load_dwordx4 v206, s[12:15], s37 offen offset:3072  lds
    s_waitcnt vmcnt(19)
    ds_read_b64_tr_b16 a[16:17], v207 offset:8192
    v_mfma_f32_32x32x16_bf16 v[0:15], a[8:11], a[44:47], v[0:15]
    ds_read_b64_tr_b16 a[18:19], v207 offset:8704
    ds_read_b64_tr_b16 a[20:21], v208 offset:8192
    v_mfma_f32_32x32x16_bf16 v[16:31], a[8:11], a[48:51], v[16:31]
    s_add_u32 s99, s99, 1
    s_cmp_eq_u32 s99, 7
    s_cselect_b32 s99, 0, s99
    s_lshl_b32 s96, s99, 19
    s_add_u32 s96, s96, s98
    s_add_u32 m0, s55, 24576
    s_lshl_b32 s37, s100, 7
    s_add_u32 s37, s37, s54
    buffer_load_dwordx4 v200, s[8:11], s37 offen offset:0  lds
    ds_read_b64_tr_b16 a[22:23], v208 offset:8704
    v_mfma_f32_32x32x16_bf16 v[32:47], a[8:11], a[52:55], v[32:47]
    ds_read_b64_tr_b16 a[24:25], v207 offset:10240
    v_mfma_f32_32x32x16_bf16 v[48:63], a[12:15], a[44:47], v[48:63]
    buffer_load_dwordx4 v201, s[8:11], s37 offen offset:1024  lds
    ds_read_b64_tr_b16 a[26:27], v207 offset:10752
    v_mfma_f32_32x32x16_bf16 v[64:79], a[12:15], a[48:51], v[64:79]
    buffer_load_dwordx4 v204, s[8:11], s37 offen offset:2048  lds
    s_add_u32 s100, s100, 1
    s_cmp_eq_u32 s100, 7
    s_cselect_b32 s100, 0, s100
    ds_read_b64_tr_b16 a[28:29], v208 offset:10240
    v_mfma_f32_32x32x16_bf16 v[80:95], a[12:15], a[52:55], v[80:95]
    ds_read_b64_tr_b16 a[30:31], v208 offset:10752
    s_waitcnt lgkmcnt(6)
    v_mfma_f32_32x32x16_bf16 v[0:15], a[16:19], a[56:59], v[0:15]
    s_add_u32 m0, s32, 16384
    s_add_u32 s37, s97, 0
    s_waitcnt lgkmcnt(0)
    buffer_load_dwordx4 v202, s[12:15], s37 offen offset:0  lds
    s_waitcnt vmcnt(16)
    s_barrier
    v_mfma_f32_32x32x16_bf16 v[16:31], a[16:19], a[60:63], v[16:31]
    ds_read_b128 a[32:35], v210 offset:12288
    v_mfma_f32_32x32x16_bf16 v[32:47], a[16:19], a[64:67], v[32:47]
    buffer_load_dwordx4 v203, s[12:15], s37 offen offset:1024  lds
    ds_read_b128 a[36:39], v210 offset:16384
    v_mfma_f32_32x32x16_bf16 v[48:63], a[20:23], a[56:59], v[48:63]
    buffer_load_dwordx4 v205, s[12:15], s37 offen offset:2048  lds
    ds_read_b128 a[40:43], v210 offset:20480
    ds_read_b128 a[44:47], v213 offset:12288
    v_mfma_f32_32x32x16_bf16 v[64:79], a[20:23], a[60:63], v[64:79]
    ds_read_b128 a[48:51], v213 offset:16384
    v_mfma_f32_32x32x16_bf16 v[80:95], a[20:23], a[64:67], v[80:95]
    buffer_load_dwordx4 v206, s[12:15], s37 offen offset:3072  lds
    ds_read_b128 a[52:55], v213 offset:20480
    v_mfma_f32_32x32x16_bf16 v[0:15], a[24:27], a[68:71], v[0:15]
    ds_read_b64_tr_b16 a[0:1], v207 offset:12288
    ds_read_b64_tr_b16 a[2:3], v207 offset:12800
    v_mfma_f32_32x32x16_bf16 v[16:31], a[24:27], a[72:75], v[16:31]
    s_add_u32 m0, s55, 36864
    s_lshl_b32 s37, s100, 7
    s_add_u32 s37, s37, s54
    buffer_load_dwordx4 v200, s[8:11], s37 offen offset:0  lds
    ds_read_b64_tr_b16 a[4:5], v208 offset:12288
    v_mfma_f32_32x32x16_bf16 v[32:47], a[24:27], a[76:79], v[32:47]
    ds_read_b64_tr_b16 a[6:7], v208 offset:12800
    v_mfma_f32_32x32x16_bf16 v[48:63], a[28:31], a[68:71], v[48:63]
    buffer_load_dwordx4 v201, s[8:11], s37 offen offset:1024  lds
    ds_read_b64_tr_b16 a[8:9], v207 offset:14336
    ds_read_b64_tr_b16 a[10:11], v207 offset:14848
    v_mfma_f32_32x32x16_bf16 v[64:79], a[28:31], a[72:75], v[64:79]
    buffer_load_dwordx4 v204, s[8:11], s37 offen offset:2048  lds
    s_add_u32 s100, s100, 1
    s_cmp_eq_u32 s100, 7
    s_cselect_b32 s100, 0, s100
    ds_read_b64_tr_b16 a[12:13], v208 offset:14336
    v_mfma_f32_32x32x16_bf16 v[80:95], a[28:31], a[76:79], v[80:95]
    ds_read_b64_tr_b16 a[14:15], v208 offset:14848
    s_waitcnt lgkmcnt(6)
    v_mfma_f32_32x32x16_bf16 v[0:15], a[0:3], a[32:35], v[0:15]
    s_add_u32 m0, s32, 20480
    s_add_u32 s37, s97, 262144
    s_waitcnt lgkmcnt(0)
    buffer_load_dwordx4 v202, s[12:15], s37 offen offset:0  lds
    ds_read_b128 a[56:59], v250 offset:12288
    ds_read_b128 a[60:63], v250 offset:16384
    v_mfma_f32_32x32x16_bf16 v[16:31], a[0:3], a[36:39], v[16:31]
    ds_read_b128 a[64:67], v250 offset:20480
    v_mfma_f32_32x32x16_bf16 v[32:47], a[0:3], a[40:43], v[32:47]
    ds_read_b128 a[68:71], v251 offset:12288
    v_mfma_f32_32x32x16_bf16 v[48:63], a[4:7], a[32:35], v[48:63]
    buffer_load_dwordx4 v203, s[12:15], s37 offen offset:1024  lds
    ds_read_b128 a[72:75], v251 offset:16384
    v_mfma_f32_32x32x16_bf16 v[64:79], a[4:7], a[36:39], v[64:79]
    ds_read_b128 a[76:79], v251 offset:20480
    v_mfma_f32_32x32x16_bf16 v[80:95], a[4:7], a[40:43], v[80:95]
    s_waitcnt vmcnt(20)
    ds_read_b64_tr_b16 a[16:17], v207 offset:16384
    v_mfma_f32_32x32x16_bf16 v[0:15], a[8:11], a[44:47], v[0:15]
    buffer_load_dwordx4 v205, s[12:15], s37 offen offset:2048  lds
    ds_read_b64_tr_b16 a[18:19], v207 offset:16896
    ds_read_b64_tr_b16 a[20:21], v208 offset:16384
    v_mfma_f32_32x32x16_bf16 v[16:31], a[8:11], a[48:51], v[16:31]
    ds_read_b64_tr_b16 a[22:23], v208 offset:16896
    v_mfma_f32_32x32x16_bf16 v[32:47], a[8:11], a[52:55], v[32:47]
    ds_read_b64_tr_b16 a[24:25], v207 offset:18432
    v_mfma_f32_32x32x16_bf16 v[48:63], a[12:15], a[44:47], v[48:63]
    buffer_load_dwordx4 v206, s[12:15], s37 offen offset:3072  lds
    s_add_u32 s99, s99, 1
    s_cmp_eq_u32 s99, 7
    s_cselect_b32 s99, 0, s99
    s_lshl_b32 s97, s99, 19
    s_add_u32 s97, s97, s98
    ds_read_b64_tr_b16 a[26:27], v207 offset:18944
    v_mfma_f32_32x32x16_bf16 v[64:79], a[12:15], a[48:51], v[64:79]
    ds_read_b64_tr_b16 a[28:29], v208 offset:18432
    v_mfma_f32_32x32x16_bf16 v[80:95], a[12:15], a[52:55], v[80:95]
    ds_read_b64_tr_b16 a[30:31], v208 offset:18944
    s_waitcnt lgkmcnt(6)
    v_mfma_f32_32x32x16_bf16 v[0:15], a[16:19], a[56:59], v[0:15]
    s_add_u32 m0, s32, 24576
    s_add_u32 s37, s96, 0
    s_waitcnt lgkmcnt(0)
    buffer_load_dwordx4 v202, s[12:15], s37 offen offset:0  lds
    s_waitcnt vmcnt(12)
    s_barrier
    v_mfma_f32_32x32x16_bf16 v[16:31], a[16:19], a[60:63], v[16:31]
    ds_read_b128 a[32:35], v210 offset:24576
    v_mfma_f32_32x32x16_bf16 v[32:47], a[16:19], a[64:67], v[32:47]
    buffer_load_dwordx4 v203, s[12:15], s37 offen offset:1024  lds
    ds_read_b128 a[36:39], v210 offset:28672
    v_mfma_f32_32x32x16_bf16 v[48:63], a[20:23], a[56:59], v[48:63]
    buffer_load_dwordx4 v205, s[12:15], s37 offen offset:2048  lds
    ds_read_b128 a[40:43], v210 offset:32768
    ds_read_b128 a[44:47], v213 offset:24576
    v_mfma_f32_32x32x16_bf16 v[64:79], a[20:23], a[60:63], v[64:79]
    ds_read_b128 a[48:51], v213 offset:28672
    v_mfma_f32_32x32x16_bf16 v[80:95], a[20:23], a[64:67], v[80:95]
    buffer_load_dwordx4 v206, s[12:15], s37 offen offset:3072  lds
    ds_read_b128 a[52:55], v213 offset:32768
    v_mfma_f32_32x32x16_bf16 v[0:15], a[24:27], a[68:71], v[0:15]
    ds_read_b64_tr_b16 a[0:1], v207 offset:0
    ds_read_b64_tr_b16 a[2:3], v207 offset:512
    v_mfma_f32_32x32x16_bf16 v[16:31], a[24:27], a[72:75], v[16:31]
    s_add_u32 m0, s55, 0
    s_lshl_b32 s37, s100, 7
    s_add_u32 s37, s37, s54
    buffer_load_dwordx4 v200, s[8:11], s37 offen offset:0  lds
    ds_read_b64_tr_b16 a[4:5], v208 offset:0
    v_mfma_f32_32x32x16_bf16 v[32:47], a[24:27], a[76:79], v[32:47]
    ds_read_b64_tr_b16 a[6:7], v208 offset:512
    v_mfma_f32_32x32x16_bf16 v[48:63], a[28:31], a[68:71], v[48:63]
    buffer_load_dwordx4 v201, s[8:11], s37 offen offset:1024  lds
    ds_read_b64_tr_b16 a[8:9], v207 offset:2048
    ds_read_b64_tr_b16 a[10:11], v207 offset:2560
    v_mfma_f32_32x32x16_bf16 v[64:79], a[28:31], a[72:75], v[64:79]
    buffer_load_dwordx4 v204, s[8:11], s37 offen offset:2048  lds
    s_add_u32 s100, s100, 1
    s_cmp_eq_u32 s100, 7
    s_cselect_b32 s100, 0, s100
    ds_read_b64_tr_b16 a[12:13], v208 offset:2048
    v_mfma_f32_32x32x16_bf16 v[80:95], a[28:31], a[76:79], v[80:95]
    ds_read_b64_tr_b16 a[14:15], v208 offset:2560
    s_waitcnt lgkmcnt(6)
    v_mfma_f32_32x32x16_bf16 v[0:15], a[0:3], a[32:35], v[0:15]
    s_add_u32 m0, s32, 8192
    s_add_u32 s37, s96, 262144
    s_waitcnt lgkmcnt(0)
    buffer_load_dwordx4 v202, s[12:15], s37 offen offset:0  lds
    ds_read_b128 a[56:59], v250 offset:24576
    ds_read_b128 a[60:63], v250 offset:28672
    v_mfma_f32_32x32x16_bf16 v[16:31], a[0:3], a[36:39], v[16:31]
    ds_read_b128 a[64:67], v250 offset:32768
    v_mfma_f32_32x32x16_bf16 v[32:47], a[0:3], a[40:43], v[32:47]
    ds_read_b128 a[68:71], v251 offset:24576
    v_mfma_f32_32x32x16_bf16 v[48:63], a[4:7], a[32:35], v[48:63]
    buffer_load_dwordx4 v203, s[12:15], s37 offen offset:1024  lds
    ds_read_b128 a[72:75], v251 offset:28672
    v_mfma_f32_32x32x16_bf16 v[64:79], a[4:7], a[36:39], v[64:79]
    ds_read_b128 a[76:79], v251 offset:32768
    v_mfma_f32_32x32x16_bf16 v[80:95], a[4:7], a[40:43], v[80:95]
    ds_read_b64_tr_b16 a[16:17], v207 offset:4096
    v_mfma_f32_32x32x16_bf16 v[0:15], a[8:11], a[44:47], v[0:15]
    buffer_load_dwordx4 v205, s[12:15], s37 offen offset:2048  lds
    ds_read_b64_tr_b16 a[18:19], v207 offset:4608
    ds_read_b64_tr_b16 a[20:21], v208 offset:4096
    v_mfma_f32_32x32x16_bf16 v[16:31], a[8:11], a[48:51], v[16:31]
    ds_read_b64_tr_b16 a[22:23], v208 offset:4608
    v_mfma_f32_32x32x16_bf16 v[32:47], a[8:11], a[52:55], v[32:47]
    ds_read_b64_tr_b16 a[24:25], v207 offset:6144
    v_mfma_f32_32x32x16_bf16 v[48:63], a[12:15], a[44:47], v[48:63]
    buffer_load_dwordx4 v206, s[12:15], s37 offen offset:3072  lds
    s_add_u32 s99, s99, 1
    s_cmp_eq_u32 s99, 7
    s_cselect_b32 s99, 0, s99
    s_lshl_b32 s96, s99, 19
    s_add_u32 s96, s96, s98
    ds_read_b64_tr_b16 a[26:27], v207 offset:6656
    v_mfma_f32_32x32x16_bf16 v[64:79], a[12:15], a[48:51], v[64:79]
    ds_read_b64_tr_b16 a[28:29], v208 offset:6144
    v_mfma_f32_32x32x16_bf16 v[80:95], a[12:15], a[52:55], v[80:95]
    ds_read_b64_tr_b16 a[30:31], v208 offset:6656
    s_waitcnt lgkmcnt(6)
    v_mfma_f32_32x32x16_bf16 v[0:15], a[16:19], a[56:59], v[0:15]
    s_add_u32 m0, s32, 12288
    s_add_u32 s37, s97, 0
    s_waitcnt lgkmcnt(0)
    buffer_load_dwordx4 v202, s[12:15], s37 offen offset:0  lds
    s_waitcnt vmcnt(16)
    s_barrier
    v_mfma_f32_32x32x16_bf16 v[16:31], a[16:19], a[60:63], v[16:31]
    ds_read_b128 a[32:35], v210 offset:36864
    v_mfma_f32_32x32x16_bf16 v[32:47], a[16:19], a[64:67], v[32:47]
    buffer_load_dwordx4 v203, s[12:15], s37 offen offset:1024  lds
    ds_read_b128 a[36:39], v210 offset:40960
    v_mfma_f32_32x32x16_bf16 v[48:63], a[20:23], a[56:59], v[48:63]
    buffer_load_dwordx4 v205, s[12:15], s37 offen offset:2048  lds
    ds_read_b128 a[40:43], v210 offset:45056
    ds_read_b128 a[44:47], v213 offset:36864
    v_mfma_f32_32x32x16_bf16 v[64:79], a[20:23], a[60:63], v[64:79]
    ds_read_b128 a[48:51], v213 offset:40960
    v_mfma_f32_32x32x16_bf16 v[80:95], a[20:23], a[64:67], v[80:95]
    buffer_load_dwordx4 v206, s[12:15], s37 offen offset:3072  lds
    ds_read_b128 a[52:55], v213 offset:45056
    v_mfma_f32_32x32x16_bf16 v[0:15], a[24:27], a[68:71], v[0:15]
    ds_read_b64_tr_b16 a[0:1], v207 offset:8192
    ds_read_b64_tr_b16 a[2:3], v207 offset:8704
    v_mfma_f32_32x32x16_bf16 v[16:31], a[24:27], a[72:75], v[16:31]
    s_add_u32 m0, s55, 12288
    s_lshl_b32 s37, s100, 7
    s_add_u32 s37, s37, s54
    buffer_load_dwordx4 v200, s[8:11], s37 offen offset:0  lds
    ds_read_b64_tr_b16 a[4:5], v208 offset:8192
    v_mfma_f32_32x32x16_bf16 v[32:47], a[24:27], a[76:79], v[32:47]
    ds_read_b64_tr_b16 a[6:7], v208 offset:8704
    v_mfma_f32_32x32x16_bf16 v[48:63], a[28:31], a[68:71], v[48:63]
    buffer_load_dwordx4 v201, s[8:11], s37 offen offset:1024  lds
    ds_read_b64_tr_b16 a[8:9], v207 offset:10240
    ds_read_b64_tr_b16 a[10:11], v207 offset:10752
    v_mfma_f32_32x32x16_bf16 v[64:79], a[28:31], a[72:75], v[64:79]
    buffer_load_dwordx4 v204, s[8:11], s37 offen offset:2048  lds
    s_add_u32 s100, s100, 1
    s_cmp_eq_u32 s100, 7
    s_cselect_b32 s100, 0, s100
    ds_read_b64_tr_b16 a[12:13], v208 offset:10240
    v_mfma_f32_32x32x16_bf16 v[80:95], a[28:31], a[76:79], v[80:95]
    ds_read_b64_tr_b16 a[14:15], v208 offset:10752
    s_waitcnt lgkmcnt(6)
    v_mfma_f32_32x32x16_bf16 v[0:15], a[0:3], a[32:35], v[0:15]
    s_add_u32 m0, s32, 16384
    s_add_u32 s37, s97, 262144
    s_waitcnt lgkmcnt(0)
    buffer_load_dwordx4 v202, s[12:15], s37 offen offset:0  lds
    ds_read_b128 a[56:59], v250 offset:36864
    ds_read_b128 a[60:63], v250 offset:40960
    v_mfma_f32_32x32x16_bf16 v[16:31], a[0:3], a[36:39], v[16:31]
    ds_read_b128 a[64:67], v250 offset:45056
    v_mfma_f32_32x32x16_bf16 v[32:47], a[0:3], a[40:43], v[32:47]
    ds_read_b128 a[68:71], v251 offset:36864
    v_mfma_f32_32x32x16_bf16 v[48:63], a[4:7], a[32:35], v[48:63]
    buffer_load_dwordx4 v203, s[12:15], s37 offen offset:1024  lds
    ds_read_b128 a[72:75], v251 offset:40960
    v_mfma_f32_32x32x16_bf16 v[64:79], a[4:7], a[36:39], v[64:79]
    ds_read_b128 a[76:79], v251 offset:45056
    v_mfma_f32_32x32x16_bf16 v[80:95], a[4:7], a[40:43], v[80:95]
    s_waitcnt vmcnt(20)
    ds_read_b64_tr_b16 a[16:17], v207 offset:12288
    v_mfma_f32_32x32x16_bf16 v[0:15], a[8:11], a[44:47], v[0:15]
    buffer_load_dwordx4 v205, s[12:15], s37 offen offset:2048  lds
    ds_read_b64_tr_b16 a[18:19], v207 offset:12800
    ds_read_b64_tr_b16 a[20:21], v208 offset:12288
    v_mfma_f32_32x32x16_bf16 v[16:31], a[8:11], a[48:51], v[16:31]
    ds_read_b64_tr_b16 a[22:23], v208 offset:12800
    v_mfma_f32_32x32x16_bf16 v[32:47], a[8:11], a[52:55], v[32:47]
    ds_read_b64_tr_b16 a[24:25], v207 offset:14336
    v_mfma_f32_32x32x16_bf16 v[48:63], a[12:15], a[44:47], v[48:63]
    buffer_load_dwordx4 v206, s[12:15], s37 offen offset:3072  lds
    ds_read_b64_tr_b16 a[26:27], v207 offset:14848
    v_mfma_f32_32x32x16_bf16 v[64:79], a[12:15], a[48:51], v[64:79]
    ds_read_b64_tr_b16 a[28:29], v208 offset:14336
    v_mfma_f32_32x32x16_bf16 v[80:95], a[12:15], a[52:55], v[80:95]
    ds_read_b64_tr_b16 a[30:31], v208 offset:14848
    s_waitcnt lgkmcnt(6)
    v_mfma_f32_32x32x16_bf16 v[0:15], a[16:19], a[56:59], v[0:15]
    s_add_u32 m0, s32, 20480
    s_add_u32 s37, s96, 0
    s_waitcnt lgkmcnt(0)
    buffer_load_dwordx4 v202, s[12:15], s37 offen offset:0  lds
    s_waitcnt vmcnt(16)
    s_barrier
    v_mfma_f32_32x32x16_bf16 v[16:31], a[16:19], a[60:63], v[16:31]
    ds_read_b128 a[32:35], v210 offset:0
    v_mfma_f32_32x32x16_bf16 v[32:47], a[16:19], a[64:67], v[32:47]
    buffer_load_dwordx4 v203, s[12:15], s37 offen offset:1024  lds
    ds_read_b128 a[36:39], v210 offset:4096
    v_mfma_f32_32x32x16_bf16 v[48:63], a[20:23], a[56:59], v[48:63]
    buffer_load_dwordx4 v205, s[12:15], s37 offen offset:2048  lds
    ds_read_b128 a[40:43], v210 offset:8192
    ds_read_b128 a[44:47], v213 offset:0
    v_mfma_f32_32x32x16_bf16 v[64:79], a[20:23], a[60:63], v[64:79]
    ds_read_b128 a[48:51], v213 offset:4096
    v_mfma_f32_32x32x16_bf16 v[80:95], a[20:23], a[64:67], v[80:95]
    buffer_load_dwordx4 v206, s[12:15], s37 offen offset:3072  lds
    ds_read_b128 a[52:55], v213 offset:8192
    v_mfma_f32_32x32x16_bf16 v[0:15], a[24:27], a[68:71], v[0:15]
    ds_read_b64_tr_b16 a[0:1], v207 offset:16384
    ds_read_b64_tr_b16 a[2:3], v207 offset:16896
    v_mfma_f32_32x32x16_bf16 v[16:31], a[24:27], a[72:75], v[16:31]
    s_add_u32 m0, s55, 24576
    s_lshl_b32 s37, s100, 7
    s_add_u32 s37, s37, s54
    buffer_load_dwordx4 v200, s[8:11], s37 offen offset:0  lds
    ds_read_b64_tr_b16 a[4:5], v208 offset:16384
    v_mfma_f32_32x32x16_bf16 v[32:47], a[24:27], a[76:79], v[32:47]
    ds_read_b64_tr_b16 a[6:7], v208 offset:16896
    v_mfma_f32_32x32x16_bf16 v[48:63], a[28:31], a[68:71], v[48:63]
    buffer_load_dwordx4 v201, s[8:11], s37 offen offset:1024  lds
    ds_read_b64_tr_b16 a[8:9], v207 offset:18432
    ds_read_b64_tr_b16 a[10:11], v207 offset:18944
    v_mfma_f32_32x32x16_bf16 v[64:79], a[28:31], a[72:75], v[64:79]
    buffer_load_dwordx4 v204, s[8:11], s37 offen offset:2048  lds
    s_add_u32 s100, s100, 1
    s_cmp_eq_u32 s100, 7
    s_cselect_b32 s100, 0, s100
    ds_read_b64_tr_b16 a[12:13], v208 offset:18432
    v_mfma_f32_32x32x16_bf16 v[80:95], a[28:31], a[76:79], v[80:95]
    ds_read_b64_tr_b16 a[14:15], v208 offset:18944
    s_waitcnt lgkmcnt(6)
    v_mfma_f32_32x32x16_bf16 v[0:15], a[0:3], a[32:35], v[0:15]
    s_add_u32 m0, s32, 24576
    s_add_u32 s37, s96, 262144
    s_waitcnt lgkmcnt(0)
    buffer_load_dwordx4 v202, s[12:15], s37 offen offset:0  lds
    ds_read_b128 a[56:59], v250 offset:0
    ds_read_b128 a[60:63], v250 offset:4096
    v_mfma_f32_32x32x16_bf16 v[16:31], a[0:3], a[36:39], v[16:31]
    ds_read_b128 a[64:67], v250 offset:8192
    v_mfma_f32_32x32x16_bf16 v[32:47], a[0:3], a[40:43], v[32:47]
    ds_read_b128 a[68:71], v251 offset:0
    v_mfma_f32_32x32x16_bf16 v[48:63], a[4:7], a[32:35], v[48:63]
    buffer_load_dwordx4 v203, s[12:15], s37 offen offset:1024  lds
    ds_read_b128 a[72:75], v251 offset:4096
    v_mfma_f32_32x32x16_bf16 v[64:79], a[4:7], a[36:39], v[64:79]
    ds_read_b128 a[76:79], v251 offset:8192
    v_mfma_f32_32x32x16_bf16 v[80:95], a[4:7], a[40:43], v[80:95]
    s_waitcnt vmcnt(20)
    ds_read_b64_tr_b16 a[16:17], v207 offset:0
    v_mfma_f32_32x32x16_bf16 v[0:15], a[8:11], a[44:47], v[0:15]
    buffer_load_dwordx4 v205, s[12:15], s37 offen offset:2048  lds
    ds_read_b64_tr_b16 a[18:19], v207 offset:512
    ds_read_b64_tr_b16 a[20:21], v208 offset:0
    v_mfma_f32_32x32x16_bf16 v[16:31], a[8:11], a[48:51], v[16:31]
    ds_read_b64_tr_b16 a[22:23], v208 offset:512
    v_mfma_f32_32x32x16_bf16 v[32:47], a[8:11], a[52:55], v[32:47]
    ds_read_b64_tr_b16 a[24:25], v207 offset:2048
    v_mfma_f32_32x32x16_bf16 v[48:63], a[12:15], a[44:47], v[48:63]
    buffer_load_dwordx4 v206, s[12:15], s37 offen offset:3072  lds
    ds_read_b64_tr_b16 a[26:27], v207 offset:2560
    v_mfma_f32_32x32x16_bf16 v[64:79], a[12:15], a[48:51], v[64:79]
    ds_read_b64_tr_b16 a[28:29], v208 offset:2048
    v_mfma_f32_32x32x16_bf16 v[80:95], a[12:15], a[52:55], v[80:95]
    ds_read_b64_tr_b16 a[30:31], v208 offset:2560
    s_waitcnt lgkmcnt(6)
    v_mfma_f32_32x32x16_bf16 v[0:15], a[16:19], a[56:59], v[0:15]
    s_add_u32 m0, s32, 0
    s_add_u32 s37, s56, 0
    buffer_load_dwordx4 v214, s[16:19], s37 offen offset:0 nt lds
    s_waitcnt vmcnt(16)
    s_barrier
    v_mfma_f32_32x32x16_bf16 v[16:31], a[16:19], a[60:63], v[16:31]
    ds_read_b128 a[32:35], v210 offset:12288
    v_mfma_f32_32x32x16_bf16 v[32:47], a[16:19], a[64:67], v[32:47]
    ds_read_b128 a[36:39], v210 offset:16384
    s_waitcnt lgkmcnt(6)
    v_mfma_f32_32x32x16_bf16 v[48:63], a[20:23], a[56:59], v[48:63]
    buffer_load_dwordx4 v215, s[16:19], s37 offen offset:1024 nt lds
    ds_read_b128 a[40:43], v210 offset:20480
    ds_read_b128 a[44:47], v213 offset:12288
    v_mfma_f32_32x32x16_bf16 v[64:79], a[20:23], a[60:63], v[64:79]
    ds_read_b128 a[48:51], v213 offset:16384
    v_mfma_f32_32x32x16_bf16 v[80:95], a[20:23], a[64:67], v[80:95]
    ds_read_b128 a[52:55], v213 offset:20480
    s_waitcnt lgkmcnt(8)
    v_mfma_f32_32x32x16_bf16 v[0:15], a[24:27], a[68:71], v[0:15]
    buffer_load_dwordx4 v216, s[16:19], s37 offen offset:2048 nt lds
    ds_read_b64_tr_b16 a[0:1], v207 offset:4096
    ds_read_b64_tr_b16 a[2:3], v207 offset:4608
    v_mfma_f32_32x32x16_bf16 v[16:31], a[24:27], a[72:75], v[16:31]
    ds_read_b64_tr_b16 a[4:5], v208 offset:4096
    v_mfma_f32_32x32x16_bf16 v[32:47], a[24:27], a[76:79], v[32:47]
    ds_read_b64_tr_b16 a[6:7], v208 offset:4608
    s_waitcnt lgkmcnt(10)
    v_mfma_f32_32x32x16_bf16 v[48:63], a[28:31], a[68:71], v[48:63]
    buffer_load_dwordx4 v217, s[16:19], s37 offen offset:3072 nt lds
    ds_read_b64_tr_b16 a[8:9], v207 offset:6144
    ds_read_b64_tr_b16 a[10:11], v207 offset:6656
    v_mfma_f32_32x32x16_bf16 v[64:79], a[28:31], a[72:75], v[64:79]
    ds_read_b64_tr_b16 a[12:13], v208 offset:6144
    v_mfma_f32_32x32x16_bf16 v[80:95], a[28:31], a[76:79], v[80:95]
    ds_read_b64_tr_b16 a[14:15], v208 offset:6656
    s_waitcnt lgkmcnt(6)
    v_mfma_f32_32x32x16_bf16 v[0:15], a[0:3], a[32:35], v[0:15]
    s_add_u32 m0, s32, 4096
    s_add_u32 s37, s56, 128
    buffer_load_dwordx4 v214, s[16:19], s37 offen offset:0 nt lds
    ds_read_b128 a[56:59], v250 offset:12288
    ds_read_b128 a[60:63], v250 offset:16384
    v_mfma_f32_32x32x16_bf16 v[16:31], a[0:3], a[36:39], v[16:31]
    ds_read_b128 a[64:67], v250 offset:20480
    v_mfma_f32_32x32x16_bf16 v[32:47], a[0:3], a[40:43], v[32:47]
    ds_read_b128 a[68:71], v251 offset:12288
    s_waitcnt lgkmcnt(8)
    v_mfma_f32_32x32x16_bf16 v[48:63], a[4:7], a[32:35], v[48:63]
    buffer_load_dwordx4 v215, s[16:19], s37 offen offset:1024 nt lds
    ds_read_b128 a[72:75], v251 offset:16384
    v_mfma_f32_32x32x16_bf16 v[64:79], a[4:7], a[36:39], v[64:79]
    ds_read_b128 a[76:79], v251 offset:20480
    v_mfma_f32_32x32x16_bf16 v[80:95], a[4:7], a[40:43], v[80:95]
    s_waitcnt vmcnt(17)
    ds_read_b64_tr_b16 a[16:17], v207 offset:8192
    s_waitcnt lgkmcnt(9)
    v_mfma_f32_32x32x16_bf16 v[0:15], a[8:11], a[44:47], v[0:15]
    buffer_load_dwordx4 v216, s[16:19], s37 offen offset:2048 nt lds
    ds_read_b64_tr_b16 a[18:19], v207 offset:8704
    ds_read_b64_tr_b16 a[20:21], v208 offset:8192
    v_mfma_f32_32x32x16_bf16 v[16:31], a[8:11], a[48:51], v[16:31]
    ds_read_b64_tr_b16 a[22:23], v208 offset:8704
    v_mfma_f32_32x32x16_bf16 v[32:47], a[8:11], a[52:55], v[32:47]
    ds_read_b64_tr_b16 a[24:25], v207 offset:10240
    s_waitcnt lgkmcnt(11)
    v_mfma_f32_32x32x16_bf16 v[48:63], a[12:15], a[44:47], v[48:63]
    buffer_load_dwordx4 v217, s[16:19], s37 offen offset:3072 nt lds
    ds_read_b64_tr_b16 a[26:27], v207 offset:10752
    v_mfma_f32_32x32x16_bf16 v[64:79], a[12:15], a[48:51], v[64:79]
    ds_read_b64_tr_b16 a[28:29], v208 offset:10240
    v_mfma_f32_32x32x16_bf16 v[80:95], a[12:15], a[52:55], v[80:95]
    ds_read_b64_tr_b16 a[30:31], v208 offset:10752
    s_waitcnt lgkmcnt(6)
    v_mfma_f32_32x32x16_bf16 v[0:15], a[16:19], a[56:59], v[0:15]
    s_waitcnt vmcnt(12)
    s_barrier
    v_mfma_f32_32x32x16_bf16 v[16:31], a[16:19], a[60:63], v[16:31]
    ds_read_b128 a[32:35], v210 offset:24576
    v_mfma_f32_32x32x16_bf16 v[32:47], a[16:19], a[64:67], v[32:47]
    ds_read_b128 a[36:39], v210 offset:28672
    s_waitcnt lgkmcnt(6)
    v_mfma_f32_32x32x16_bf16 v[48:63], a[20:23], a[56:59], v[48:63]
    ds_read_b128 a[40:43], v210 offset:32768
    ds_read_b128 a[44:47], v213 offset:24576
    v_mfma_f32_32x32x16_bf16 v[64:79], a[20:23], a[60:63], v[64:79]
    ds_read_b128 a[48:51], v213 offset:28672
    v_mfma_f32_32x32x16_bf16 v[80:95], a[20:23], a[64:67], v[80:95]
    ds_read_b128 a[52:55], v213 offset:32768
    s_waitcnt lgkmcnt(8)
    v_mfma_f32_32x32x16_bf16 v[0:15], a[24:27], a[68:71], v[0:15]
    ds_read_b64_tr_b16 a[0:1], v207 offset:12288
    ds_read_b64_tr_b16 a[2:3], v207 offset:12800
    v_mfma_f32_32x32x16_bf16 v[16:31], a[24:27], a[72:75], v[16:31]
    ds_read_b64_tr_b16 a[4:5], v208 offset:12288
    v_mfma_f32_32x32x16_bf16 v[32:47], a[24:27], a[76:79], v[32:47]
    ds_read_b64_tr_b16 a[6:7], v208 offset:12800
    s_waitcnt lgkmcnt(10)
    v_mfma_f32_32x32x16_bf16 v[48:63], a[28:31], a[68:71], v[48:63]
    ds_read_b64_tr_b16 a[8:9], v207 offset:14336
    ds_read_b64_tr_b16 a[10:11], v207 offset:14848
    v_mfma_f32_32x32x16_bf16 v[64:79], a[28:31], a[72:75], v[64:79]
    ds_read_b64_tr_b16 a[12:13], v208 offset:14336
    v_mfma_f32_32x32x16_bf16 v[80:95], a[28:31], a[76:79], v[80:95]
    ds_read_b64_tr_b16 a[14:15], v208 offset:14848
    s_waitcnt lgkmcnt(6)
    v_mfma_f32_32x32x16_bf16 v[0:15], a[0:3], a[32:35], v[0:15]
    s_add_u32 m0, s32, 8192
    s_add_u32 s37, s56, 256
    buffer_load_dwordx4 v214, s[16:19], s37 offen offset:0 nt lds
    ds_read_b128 a[56:59], v250 offset:24576
    ds_read_b128 a[60:63], v250 offset:28672
    v_mfma_f32_32x32x16_bf16 v[16:31], a[0:3], a[36:39], v[16:31]
    ds_read_b128 a[64:67], v250 offset:32768
    v_mfma_f32_32x32x16_bf16 v[32:47], a[0:3], a[40:43], v[32:47]
    ds_read_b128 a[68:71], v251 offset:24576
    s_waitcnt lgkmcnt(8)
    v_mfma_f32_32x32x16_bf16 v[48:63], a[4:7], a[32:35], v[48:63]
    buffer_load_dwordx4 v215, s[16:19], s37 offen offset:1024 nt lds
    ds_read_b128 a[72:75], v251 offset:28672
    v_mfma_f32_32x32x16_bf16 v[64:79], a[4:7], a[36:39], v[64:79]
    ds_read_b128 a[76:79], v251 offset:32768
    v_mfma_f32_32x32x16_bf16 v[80:95], a[4:7], a[40:43], v[80:95]
    s_waitcnt vmcnt(10)
    ds_read_b64_tr_b16 a[16:17], v207 offset:16384
    s_waitcnt lgkmcnt(9)
    v_mfma_f32_32x32x16_bf16 v[0:15], a[8:11], a[44:47], v[0:15]
    buffer_load_dwordx4 v216, s[16:19], s37 offen offset:2048 nt lds
    ds_read_b64_tr_b16 a[18:19], v207 offset:16896
    ds_read_b64_tr_b16 a[20:21], v208 offset:16384
    v_mfma_f32_32x32x16_bf16 v[16:31], a[8:11], a[48:51], v[16:31]
    ds_read_b64_tr_b16 a[22:23], v208 offset:16896
    v_mfma_f32_32x32x16_bf16 v[32:47], a[8:11], a[52:55], v[32:47]
    ds_read_b64_tr_b16 a[24:25], v207 offset:18432
    s_waitcnt lgkmcnt(11)
    v_mfma_f32_32x32x16_bf16 v[48:63], a[12:15], a[44:47], v[48:63]
    buffer_load_dwordx4 v217, s[16:19], s37 offen offset:3072 nt lds
    ds_read_b64_tr_b16 a[26:27], v207 offset:18944
    v_mfma_f32_32x32x16_bf16 v[64:79], a[12:15], a[48:51], v[64:79]
    ds_read_b64_tr_b16 a[28:29], v208 offset:18432
    v_mfma_f32_32x32x16_bf16 v[80:95], a[12:15], a[52:55], v[80:95]
    ds_read_b64_tr_b16 a[30:31], v208 offset:18944
    s_waitcnt lgkmcnt(6)
    v_mfma_f32_32x32x16_bf16 v[0:15], a[16:19], a[56:59], v[0:15]
    s_waitcnt lgkmcnt(0)
    s_barrier
    v_mfma_f32_32x32x16_bf16 v[16:31], a[16:19], a[60:63], v[16:31]
    s_add_u32 m0, s32, 12288
    s_add_u32 s37, s56, 384
    buffer_load_dwordx4 v214, s[16:19], s37 offen offset:0 nt lds
    v_mfma_f32_32x32x16_bf16 v[32:47], a[16:19], a[64:67], v[32:47]
    v_mfma_f32_32x32x16_bf16 v[48:63], a[20:23], a[56:59], v[48:63]
    v_mfma_f32_32x32x16_bf16 v[64:79], a[20:23], a[60:63], v[64:79]
    buffer_load_dwordx4 v215, s[16:19], s37 offen offset:1024 nt lds
    v_mfma_f32_32x32x16_bf16 v[80:95], a[20:23], a[64:67], v[80:95]
    v_mfma_f32_32x32x16_bf16 v[0:15], a[24:27], a[68:71], v[0:15]
    v_mfma_f32_32x32x16_bf16 v[16:31], a[24:27], a[72:75], v[16:31]
    buffer_load_dwordx4 v216, s[16:19], s37 offen offset:2048 nt lds
    v_mfma_f32_32x32x16_bf16 v[32:47], a[24:27], a[76:79], v[32:47]
    v_mfma_f32_32x32x16_bf16 v[48:63], a[28:31], a[68:71], v[48:63]
    buffer_load_dwordx4 v217, s[16:19], s37 offen offset:3072 nt lds
    v_mfma_f32_32x32x16_bf16 v[64:79], a[28:31], a[72:75], v[64:79]
    v_mfma_f32_32x32x16_bf16 v[80:95], a[28:31], a[76:79], v[80:95]
    s_add_u32 m0, s32, 16384
    s_add_u32 s37, s52, 65536
    buffer_load_dwordx4 v214, s[16:19], s37 offen offset:0 nt lds
    s_nop 1
    v_cvt_pk_bf16_f32 v0, v0, v1
    v_cvt_pk_bf16_f32 v1, v2, v3
    v_cvt_pk_bf16_f32 v2, v4, v5
    v_cvt_pk_bf16_f32 v3, v6, v7
    ds_write_b128 v249, v[0:3] offset:0
    v_cvt_pk_bf16_f32 v16, v16, v17
    v_cvt_pk_bf16_f32 v17, v18, v19
    buffer_load_dwordx4 v215, s[16:19], s37 offen offset:1024 nt lds
    v_cvt_pk_bf16_f32 v18, v20, v21
    v_cvt_pk_bf16_f32 v19, v22, v23
    ds_write_b128 v249, v[16:19] offset:16384
    v_cvt_pk_bf16_f32 v32, v32, v33
    v_cvt_pk_bf16_f32 v33, v34, v35
    v_cvt_pk_bf16_f32 v34, v36, v37
    v_cvt_pk_bf16_f32 v35, v38, v39
    ds_write_b128 v249, v[32:35] offset:32768
    buffer_load_dwordx4 v216, s[16:19], s37 offen offset:2048 nt lds
    v_xor_b32 v211, 32, v249
    v_cvt_pk_bf16_f32 v8, v8, v9
    v_cvt_pk_bf16_f32 v9, v10, v11
    v_cvt_pk_bf16_f32 v10, v12, v13
    v_cvt_pk_bf16_f32 v11, v14, v15
    ds_write_b128 v211, v[8:11] offset:0
    v_cvt_pk_bf16_f32 v24, v24, v25
    v_cvt_pk_bf16_f32 v25, v26, v27
    buffer_load_dwordx4 v217, s[16:19], s37 offen offset:3072 nt lds
    v_cvt_pk_bf16_f32 v26, v28, v29
    v_cvt_pk_bf16_f32 v27, v30, v31
    ds_write_b128 v211, v[24:27] offset:16384
    v_cvt_pk_bf16_f32 v40, v40, v41
    v_cvt_pk_bf16_f32 v41, v42, v43
    v_cvt_pk_bf16_f32 v42, v44, v45
    v_cvt_pk_bf16_f32 v43, v46, v47
    ds_write_b128 v211, v[40:43] offset:32768
    s_add_u32 m0, s32, 20480
    s_add_u32 s37, s52, 65664
    buffer_load_dwordx4 v214, s[16:19], s37 offen offset:0 nt lds
    v_xor_b32 v211, 64, v249
    v_cvt_pk_bf16_f32 v48, v48, v49
    v_cvt_pk_bf16_f32 v49, v50, v51
    v_cvt_pk_bf16_f32 v50, v52, v53
    v_cvt_pk_bf16_f32 v51, v54, v55
    ds_write_b128 v211, v[48:51] offset:0
    v_cvt_pk_bf16_f32 v64, v64, v65
    v_cvt_pk_bf16_f32 v65, v66, v67
    buffer_load_dwordx4 v215, s[16:19], s37 offen offset:1024 nt lds
    v_cvt_pk_bf16_f32 v66, v68, v69
    v_cvt_pk_bf16_f32 v67, v70, v71
    ds_write_b128 v211, v[64:67] offset:16384
    v_cvt_pk_bf16_f32 v80, v80, v81
    v_cvt_pk_bf16_f32 v81, v82, v83
    v_cvt_pk_bf16_f32 v82, v84, v85
    v_cvt_pk_bf16_f32 v83, v86, v87
    ds_write_b128 v211, v[80:83] offset:32768
    buffer_load_dwordx4 v216, s[16:19], s37 offen offset:2048 nt lds
    v_xor_b32 v211, 96, v249
    v_cvt_pk_bf16_f32 v56, v56, v57
    v_cvt_pk_bf16_f32 v57, v58, v59
    v_cvt_pk_bf16_f32 v58, v60, v61
    v_cvt_pk_bf16_f32 v59, v62, v63
    ds_write_b128 v211, v[56:59] offset:0
    v_cvt_pk_bf16_f32 v72, v72, v73
    v_cvt_pk_bf16_f32 v73, v74, v75
    buffer_load_dwordx4 v217, s[16:19], s37 offen offset:3072 nt lds
    v_cvt_pk_bf16_f32 v74, v76, v77
    v_cvt_pk_bf16_f32 v75, v78, v79
    ds_write_b128 v211, v[72:75] offset:16384
    v_cvt_pk_bf16_f32 v88, v88, v89
    v_cvt_pk_bf16_f32 v89, v90, v91
    v_cvt_pk_bf16_f32 v90, v92, v93
    v_cvt_pk_bf16_f32 v91, v94, v95
    ds_write_b128 v211, v[88:91] offset:32768
    s_waitcnt lgkmcnt(0)
    s_barrier
    s_waitcnt vmcnt(20)
    ds_read_b128 a[192:195], v218 offset:0
    ds_read_b128 a[196:199], v219 offset:0
    ds_read_b128 a[200:203], v220 offset:0
    ds_read_b128 a[204:207], v221 offset:0
    ds_read_b128 a[0:3], v212 offset:0
    ds_read_b128 a[64:67], v212 offset:16384
    ds_read_b128 a[128:131], v212 offset:32768
    v_xor_b32 v213, 32, v212
    ds_read_b128 a[4:7], v213 offset:0
    ds_read_b128 a[68:71], v213 offset:16384
    ds_read_b128 a[132:135], v213 offset:32768
    v_xor_b32 v213, 64, v212
    ds_read_b128 a[8:11], v213 offset:0
    ds_read_b128 a[72:75], v213 offset:16384
    ds_read_b128 a[136:139], v213 offset:32768
    v_xor_b32 v213, 96, v212
    ds_read_b128 a[12:15], v213 offset:0
    ds_read_b128 a[76:79], v213 offset:16384
    ds_read_b128 a[140:143], v213 offset:32768
    s_waitcnt lgkmcnt(11)
    v_mfma_f32_32x32x16_bf16 v[0:15], a[192:195], a[0:3], 0
    s_add_u32 m0, s32, 24576
    s_add_u32 s37, s52, 65792
    buffer_load_dwordx4 v214, s[16:19], s37 offen offset:0 nt lds
    v_xor_b32 v213, 128, v212
    ds_read_b128 a[16:19], v213 offset:0
    s_waitcnt lgkmcnt(11)
    v_mfma_f32_32x32x16_bf16 v[16:31], a[192:195], a[64:67], 0
    ds_read_b128 a[80:83], v213 offset:16384
    ds_read_b128 a[144:147], v213 offset:32768
    s_waitcnt lgkmcnt(12)
    v_mfma_f32_32x32x16_bf16 v[32:47], a[192:195], a[128:131], 0
    v_xor_b32 v213, 160, v212
    s_waitcnt lgkmcnt(11)
    v_mfma_f32_32x32x16_bf16 v[0:15], a[196:199], a[4:7], v[0:15]
    buffer_load_dwordx4 v215, s[16:19], s37 offen offset:1024 nt lds
    ds_read_b128 a[20:23], v213 offset:0
    ds_read_b128 a[84:87], v213 offset:16384
    s_waitcnt lgkmcnt(12)
    v_mfma_f32_32x32x16_bf16 v[16:31], a[196:199], a[68:71], v[16:31]
    ds_read_b128 a[148:151], v213 offset:32768
    v_xor_b32 v213, 192, v212
    s_waitcnt lgkmcnt(12)
    v_mfma_f32_32x32x16_bf16 v[32:47], a[196:199], a[132:135], v[32:47]
    ds_read_b128 a[24:27], v213 offset:0
    s_waitcnt lgkmcnt(12)
    v_mfma_f32_32x32x16_bf16 v[0:15], a[200:203], a[8:11], v[0:15]
    buffer_load_dwordx4 v216, s[16:19], s37 offen offset:2048 nt lds
    ds_read_b128 a[88:91], v213 offset:16384
    ds_read_b128 a[152:155], v213 offset:32768
    s_waitcnt lgkmcnt(13)
    v_mfma_f32_32x32x16_bf16 v[16:31], a[200:203], a[72:75], v[16:31]
    v_xor_b32 v213, 224, v212
    ds_read_b128 a[28:31], v213 offset:0
    s_waitcnt lgkmcnt(13)
    v_mfma_f32_32x32x16_bf16 v[32:47], a[200:203], a[136:139], v[32:47]
    ds_read_b128 a[92:95], v213 offset:16384
    s_waitcnt lgkmcnt(13)
    v_mfma_f32_32x32x16_bf16 v[0:15], a[204:207], a[12:15], v[0:15]
    buffer_load_dwordx4 v217, s[16:19], s37 offen offset:3072 nt lds
    ds_read_b128 a[156:159], v213 offset:32768
    s_waitcnt vmcnt(20)
    ds_read_b128 a[208:211], v218 offset:4096
    s_waitcnt lgkmcnt(14)
    v_mfma_f32_32x32x16_bf16 v[16:31], a[204:207], a[76:79], v[16:31]
    ds_read_b128 a[212:215], v219 offset:4096
    ds_read_b128 a[216:219], v220 offset:4096
    s_waitcnt lgkmcnt(15)
    v_mfma_f32_32x32x16_bf16 v[32:47], a[204:207], a[140:143], v[32:47]
    ds_read_b128 a[220:223], v221 offset:4096
    s_waitcnt lgkmcnt(3)
    v_mfma_f32_32x32x16_bf16 v[0:15], a[208:211], a[16:19], v[0:15]
    s_add_u32 m0, s32, 0
    s_add_u32 s37, s52, 65920
    buffer_load_dwordx4 v214, s[16:19], s37 offen offset:0 nt lds
    v_xor_b32 v213, 256, v212
    ds_read_b128 a[32:35], v213 offset:0
    v_mfma_f32_32x32x16_bf16 v[16:31], a[208:211], a[80:83], v[16:31]
    ds_read_b128 a[96:99], v213 offset:16384
    ds_read_b128 a[160:163], v213 offset:32768
    v_mfma_f32_32x32x16_bf16 v[32:47], a[208:211], a[144:147], v[32:47]
    v_xor_b32 v213, 288, v212
    s_waitcnt lgkmcnt(5)
    v_mfma_f32_32x32x16_bf16 v[0:15], a[212:215], a[20:23], v[0:15]
    buffer_load_dwordx4 v215, s[16:19], s37 offen offset:1024 nt lds
    ds_read_b128 a[36:39], v213 offset:0
    ds_read_b128 a[100:103], v213 offset:16384
    v_mfma_f32_32x32x16_bf16 v[16:31], a[212:215], a[84:87], v[16:31]
    ds_read_b128 a[164:167], v213 offset:32768
    v_xor_b32 v213, 320, v212
    v_mfma_f32_32x32x16_bf16 v[32:47], a[212:215], a[148:151], v[32:47]
    ds_read_b128 a[40:43], v213 offset:0
    s_waitcnt lgkmcnt(8)
    v_mfma_f32_32x32x16_bf16 v[0:15], a[216:219], a[24:27], v[0:15]
    buffer_load_dwordx4 v216, s[16:19], s37 offen offset:2048 nt lds
    ds_read_b128 a[104:107], v213 offset:16384
    ds_read_b128 a[168:171], v213 offset:32768
    v_mfma_f32_32x32x16_bf16 v[16:31], a[216:219], a[88:91], v[16:31]
    v_xor_b32 v213, 352, v212
    ds_read_b128 a[44:47], v213 offset:0
    v_mfma_f32_32x32x16_bf16 v[32:47], a[216:219], a[152:155], v[32:47]
    ds_read_b128 a[108:111], v213 offset:16384
    s_waitcnt lgkmcnt(11)
    v_mfma_f32_32x32x16_bf16 v[0:15], a[220:223], a[28:31], v[0:15]
    buffer_load_dwordx4 v217, s[16:19], s37 offen offset:3072 nt lds
    ds_read_b128 a[172:175], v213 offset:32768
    s_waitcnt vmcnt(20)
    ds_read_b128 a[192:195], v218 offset:8192
    v_mfma_f32_32x32x16_bf16 v[16:31], a[220:223], a[92:95], v[16:31]
    ds_read_b128 a[196:199], v219 offset:8192
    ds_read_b128 a[200:203], v220 offset:8192
    v_mfma_f32_32x32x16_bf16 v[32:47], a[220:223], a[156:159], v[32:47]
    ds_read_b128 a[204:207], v221 offset:8192
    s_waitcnt lgkmcnt(3)
    v_mfma_f32_32x32x16_bf16 v[0:15], a[192:195], a[32:35], v[0:15]
    s_add_u32 m0, s32, 4096
    s_add_u32 s37, s56, 131072
    buffer_load_dwordx4 v214, s[16:19], s37 offen offset:0 nt lds
    v_xor_b32 v213, 384, v212
    ds_read_b128 a[48:51], v213 offset:0
    v_mfma_f32_32x32x16_bf16 v[16:31], a[192:195], a[96:99], v[16:31]
    ds_read_b128 a[112:115], v213 offset:16384
    ds_read_b128 a[176:179], v213 offset:32768
    v_mfma_f32_32x32x16_bf16 v[32:47], a[192:195], a[160:163], v[32:47]
    v_xor_b32 v213, 416, v212
    s_waitcnt lgkmcnt(5)
    v_mfma_f32_32x32x16_bf16 v[0:15], a[196:199], a[36:39], v[0:15]
    buffer_load_dwordx4 v215, s[16:19], s37 offen offset:1024 nt lds
    ds_read_b128 a[52:55], v213 offset:0
    ds_read_b128 a[116:119], v213 offset:16384
    v_mfma_f32_32x32x16_bf16 v[16:31], a[196:199], a[100:103], v[16:31]
    ds_read_b128 a[180:183], v213 offset:32768
    v_xor_b32 v213, 448, v212
    v_mfma_f32_32x32x16_bf16 v[32:47], a[196:199], a[164:167], v[32:47]
    ds_read_b128 a[56:59], v213 offset:0
    s_waitcnt lgkmcnt(8)
    v_mfma_f32_32x32x16_bf16 v[0:15], a[200:203], a[40:43], v[0:15]
    buffer_load_dwordx4 v216, s[16:19], s37 offen offset:2048 nt lds
    ds_read_b128 a[120:123], v213 offset:16384
    ds_read_b128 a[184:187], v213 offset:32768
    v_mfma_f32_32x32x16_bf16 v[16:31], a[200:203], a[104:107], v[16:31]
    v_xor_b32 v213, 480, v212
    ds_read_b128 a[60:63], v213 offset:0
    v_mfma_f32_32x32x16_bf16 v[32:47], a[200:203], a[168:171], v[32:47]
    ds_read_b128 a[124:127], v213 offset:16384
    s_waitcnt lgkmcnt(11)
    v_mfma_f32_32x32x16_bf16 v[0:15], a[204:207], a[44:47], v[0:15]
    buffer_load_dwordx4 v217, s[16:19], s37 offen offset:3072 nt lds
    ds_read_b128 a[188:191], v213 offset:32768
    s_waitcnt vmcnt(20)
    ds_read_b128 a[208:211], v218 offset:12288
    v_mfma_f32_32x32x16_bf16 v[16:31], a[204:207], a[108:111], v[16:31]
    ds_read_b128 a[212:215], v219 offset:12288
    ds_read_b128 a[216:219], v220 offset:12288
    v_mfma_f32_32x32x16_bf16 v[32:47], a[204:207], a[172:175], v[32:47]
    ds_read_b128 a[220:223], v221 offset:12288
    s_waitcnt lgkmcnt(3)
    v_mfma_f32_32x32x16_bf16 v[0:15], a[208:211], a[48:51], v[0:15]
    s_waitcnt vmcnt(16)
    ds_read_b128 a[192:195], v218 offset:16384
    v_mfma_f32_32x32x16_bf16 v[16:31], a[208:211], a[112:115], v[16:31]
    v_mfma_f32_32x32x16_bf16 v[32:47], a[208:211], a[176:179], v[32:47]
    s_waitcnt lgkmcnt(3)
    v_mfma_f32_32x32x16_bf16 v[0:15], a[212:215], a[52:55], v[0:15]
    ds_read_b128 a[196:199], v219 offset:16384
    v_mfma_f32_32x32x16_bf16 v[16:31], a[212:215], a[116:119], v[16:31]
    v_mfma_f32_32x32x16_bf16 v[32:47], a[212:215], a[180:183], v[32:47]
    s_waitcnt lgkmcnt(3)
    v_mfma_f32_32x32x16_bf16 v[0:15], a[216:219], a[56:59], v[0:15]
    ds_read_b128 a[200:203], v220 offset:16384
    v_mfma_f32_32x32x16_bf16 v[16:31], a[216:219], a[120:123], v[16:31]
    v_mfma_f32_32x32x16_bf16 v[32:47], a[216:219], a[184:187], v[32:47]
    s_waitcnt lgkmcnt(3)
    v_mfma_f32_32x32x16_bf16 v[0:15], a[220:223], a[60:63], v[0:15]
    ds_read_b128 a[204:207], v221 offset:16384
    v_mfma_f32_32x32x16_bf16 v[16:31], a[220:223], a[124:127], v[16:31]
    v_mfma_f32_32x32x16_bf16 v[32:47], a[220:223], a[188:191], v[32:47]
    s_barrier
    s_waitcnt lgkmcnt(3)
    v_mfma_f32_32x32x16_bf16 v[48:63], a[192:195], a[0:3], 0
    s_add_u32 m0, s32, 8192
    s_add_u32 s37, s56, 131200
    buffer_load_dwordx4 v214, s[16:19], s37 offen offset:0 nt lds
    s_waitcnt vmcnt(13)
    ds_read_b128 a[208:211], v218 offset:20480
    s_nop 0
    v_max_f32 v238, v0, v1
    v_max3_f32 v238, v2, v3, v238
    v_mfma_f32_32x32x16_bf16 v[64:79], a[192:195], a[64:67], 0
    v_max3_f32 v238, v4, v5, v238
    v_max3_f32 v238, v6, v7, v238
    v_mfma_f32_32x32x16_bf16 v[80:95], a[192:195], a[128:131], 0
    v_max3_f32 v238, v8, v9, v238
    v_max3_f32 v238, v10, v11, v238
    s_waitcnt lgkmcnt(3)
    v_mfma_f32_32x32x16_bf16 v[48:63], a[196:199], a[4:7], v[48:63]
    buffer_load_dwordx4 v215, s[16:19], s37 offen offset:1024 nt lds
    ds_read_b128 a[212:215], v219 offset:20480
    v_lshlrev_b32 v200, 4, v255
    v_mul_u32_u24 v195, 0x124a, v255
    v_mfma_f32_32x32x16_bf16 v[64:79], a[196:199], a[68:71], v[64:79]
    v_lshrrev_b32 v195, 16, v195
    v_mul_u32_u24 v195, 0x2a0, v195
    v_mfma_f32_32x32x16_bf16 v[80:95], a[196:199], a[132:135], v[80:95]
    v_add_u32 v200, v200, v195
    v_add_u32 v201, 64, v255
    s_waitcnt lgkmcnt(3)
    v_mfma_f32_32x32x16_bf16 v[48:63], a[200:203], a[8:11], v[48:63]
    buffer_load_dwordx4 v216, s[16:19], s37 offen offset:2048 nt lds
    ds_read_b128 a[216:219], v220 offset:20480
    v_lshlrev_b32 v201, 4, v201
    v_add_u32 v195, 64, v255
    v_mfma_f32_32x32x16_bf16 v[64:79], a[200:203], a[72:75], v[64:79]
    v_mul_u32_u24 v195, 0x124a, v195
    v_lshrrev_b32 v195, 16, v195
    v_mfma_f32_32x32x16_bf16 v[80:95], a[200:203], a[136:139], v[80:95]
    v_mul_u32_u24 v195, 0x2a0, v195
    v_add_u32 v201, v201, v195
    s_waitcnt lgkmcnt(3)
    v_mfma_f32_32x32x16_bf16 v[48:63], a[204:207], a[12:15], v[48:63]
    buffer_load_dwordx4 v217, s[16:19], s37 offen offset:3072 nt lds
    ds_read_b128 a[220:223], v221 offset:20480
    v_add_u32 v201, 0xfffffc00, v201
    v_add_u32 v202, 0x80, v255
    v_mfma_f32_32x32x16_bf16 v[64:79], a[204:207], a[76:79], v[64:79]
    v_lshlrev_b32 v202, 4, v202
    v_add_u32 v195, 0x80, v255
    v_mfma_f32_32x32x16_bf16 v[80:95], a[204:207], a[140:143], v[80:95]
    v_mul_u32_u24 v195, 0x124a, v195
    v_lshrrev_b32 v195, 16, v195
    s_waitcnt lgkmcnt(3)
    v_mfma_f32_32x32x16_bf16 v[48:63], a[208:211], a[16:19], v[48:63]
    s_add_u32 m0, s32, 12288
    s_add_u32 s37, s56, 131328
    buffer_load_dwordx4 v214, s[16:19], s37 offen offset:0 nt lds
    s_waitcnt vmcnt(13)
    ds_read_b128 a[192:195], v218 offset:24576
    v_max3_f32 v238, v12, v13, v238
    v_max3_f32 v238, v14, v15, v238
    v_max_f32 v239, v16, v17
    v_mfma_f32_32x32x16_bf16 v[64:79], a[208:211], a[80:83], v[64:79]
    v_max3_f32 v239, v18, v19, v239
    v_max3_f32 v239, v20, v21, v239
    v_mfma_f32_32x32x16_bf16 v[80:95], a[208:211], a[144:147], v[80:95]
    v_max3_f32 v239, v22, v23, v239
    v_mul_u32_u24 v195, 0x2a0, v195
    s_waitcnt lgkmcnt(3)
    v_mfma_f32_32x32x16_bf16 v[48:63], a[212:215], a[20:23], v[48:63]
    buffer_load_dwordx4 v215, s[16:19], s37 offen offset:1024 nt lds
    ds_read_b128 a[196:199], v219 offset:24576
    v_add_u32 v202, v202, v195
    v_add_u32 v202, 0xfffff800, v202
    v_mfma_f32_32x32x16_bf16 v[64:79], a[212:215], a[84:87], v[64:79]
    v_add_u32 v203, 0xc0, v255
    v_lshlrev_b32 v203, 4, v203
    v_mfma_f32_32x32x16_bf16 v[80:95], a[212:215], a[148:151], v[80:95]
    v_add_u32 v195, 0xc0, v255
    v_mul_u32_u24 v195, 0x124a, v195
    s_waitcnt lgkmcnt(3)
    v_mfma_f32_32x32x16_bf16 v[48:63], a[216:219], a[24:27], v[48:63]
    buffer_load_dwordx4 v216, s[16:19], s37 offen offset:2048 nt lds
    ds_read_b128 a[200:203], v220 offset:24576
    v_lshrrev_b32 v195, 16, v195
    v_mul_u32_u24 v195, 0x2a0, v195
    v_mfma_f32_32x32x16_bf16 v[64:79], a[216:219], a[88:91], v[64:79]
    v_add_u32 v203, v203, v195
    v_add_u32 v203, 0xfffff400, v203
    v_mfma_f32_32x32x16_bf16 v[80:95], a[216:219], a[152:155], v[80:95]
    v_add_u32 v204, 0x100, v255
    v_lshlrev_b32 v204, 4, v204
    s_waitcnt lgkmcnt(3)
    v_mfma_f32_32x32x16_bf16 v[48:63], a[220:223], a[28:31], v[48:63]
    buffer_load_dwordx4 v217, s[16:19], s37 offen offset:3072 nt lds
    ds_read_b128 a[204:207], v221 offset:24576
    v_add_u32 v195, 0x100, v255
    v_mul_u32_u24 v195, 0x124a, v195
    v_mfma_f32_32x32x16_bf16 v[64:79], a[220:223], a[92:95], v[64:79]
    v_lshrrev_b32 v195, 16, v195
    v_mul_u32_u24 v195, 0x2a0, v195
    v_mfma_f32_32x32x16_bf16 v[80:95], a[220:223], a[156:159], v[80:95]
    v_add_u32 v204, v204, v195
    v_add_u32 v205, 0x140, v255
    s_waitcnt lgkmcnt(3)
    v_mfma_f32_32x32x16_bf16 v[48:63], a[192:195], a[32:35], v[48:63]
    s_add_u32 m0, s32, 16384
    s_add_u32 s37, s56, 131456
    buffer_load_dwordx4 v214, s[16:19], s37 offen offset:0 nt lds
    s_waitcnt vmcnt(13)
    ds_read_b128 a[208:211], v218 offset:0
    v_max3_f32 v239, v24, v25, v239
    v_max3_f32 v239, v26, v27, v239
    v_max3_f32 v239, v28, v29, v239
    v_mfma_f32_32x32x16_bf16 v[64:79], a[192:195], a[96:99], v[64:79]
    v_max3_f32 v239, v30, v31, v239
    v_max_f32 v240, v32, v33
    v_mfma_f32_32x32x16_bf16 v[80:95], a[192:195], a[160:163], v[80:95]
    v_max3_f32 v240, v34, v35, v240
    v_lshlrev_b32 v205, 4, v205
    s_waitcnt lgkmcnt(3)
    v_mfma_f32_32x32x16_bf16 v[48:63], a[196:199], a[36:39], v[48:63]
    buffer_load_dwordx4 v215, s[16:19], s37 offen offset:1024 nt lds
    ds_read_b128 a[212:215], v219 offset:0
    v_add_u32 v195, 0x140, v255
    v_mul_u32_u24 v195, 0x124a, v195
    v_mfma_f32_32x32x16_bf16 v[64:79], a[196:199], a[100:103], v[64:79]
    v_lshrrev_b32 v195, 16, v195
    v_mul_u32_u24 v195, 0x2a0, v195
    v_mfma_f32_32x32x16_bf16 v[80:95], a[196:199], a[164:167], v[80:95]
    v_add_u32 v205, v205, v195
    v_add_u32 v205, 0xfffffc00, v205
    s_waitcnt lgkmcnt(3)
    v_mfma_f32_32x32x16_bf16 v[48:63], a[200:203], a[40:43], v[48:63]
    buffer_load_dwordx4 v216, s[16:19], s37 offen offset:2048 nt lds
    ds_read_b128 a[216:219], v220 offset:0
    v_add_u32 v206, 0x180, v255
    v_lshlrev_b32 v206, 4, v206
    v_mfma_f32_32x32x16_bf16 v[64:79], a[200:203], a[104:107], v[64:79]
    v_add_u32 v195, 0x180, v255
    v_mul_u32_u24 v195, 0x124a, v195
    v_mfma_f32_32x32x16_bf16 v[80:95], a[200:203], a[168:171], v[80:95]
    v_lshrrev_b32 v195, 16, v195
    v_mul_u32_u24 v195, 0x2a0, v195
    s_waitcnt lgkmcnt(3)
    v_mfma_f32_32x32x16_bf16 v[48:63], a[204:207], a[44:47], v[48:63]
    buffer_load_dwordx4 v217, s[16:19], s37 offen offset:3072 nt lds
    ds_read_b128 a[220:223], v221 offset:0
    v_add_u32 v206, v206, v195
    v_add_u32 v206, 0xfffff800, v206
    v_mfma_f32_32x32x16_bf16 v[64:79], a[204:207], a[108:111], v[64:79]
    v_lshrrev_b32 v207, 4, v255
    v_lshrrev_b32 v207, 1, v207
    v_mfma_f32_32x32x16_bf16 v[80:95], a[204:207], a[172:175], v[80:95]
    v_lshlrev_b32 v207, 4, v207
    v_lshrrev_b32 v195, 4, v255
    s_waitcnt lgkmcnt(3)
    v_mfma_f32_32x32x16_bf16 v[48:63], a[208:211], a[48:51], v[48:63]
    s_waitcnt vmcnt(12)
    ds_read_b128 a[192:195], v218 offset:4096
    v_max3_f32 v240, v36, v37, v240
    v_max3_f32 v240, v38, v39, v240
    v_max3_f32 v240, v40, v41, v240
    v_mfma_f32_32x32x16_bf16 v[64:79], a[208:211], a[112:115], v[64:79]
    v_max3_f32 v240, v42, v43, v240
    v_max3_f32 v240, v44, v45, v240
    v_mfma_f32_32x32x16_bf16 v[80:95], a[208:211], a[176:179], v[80:95]
    v_max3_f32 v240, v46, v47, v240
    v_and_b32 v195, 1, v195
    s_waitcnt lgkmcnt(3)
    v_mfma_f32_32x32x16_bf16 v[48:63], a[212:215], a[52:55], v[48:63]
    ds_read_b128 a[196:199], v219 offset:4096
    v_lshlrev_b32 v195, 2, v195
    v_add_u32 v207, v207, v195
    v_mfma_f32_32x32x16_bf16 v[64:79], a[212:215], a[116:119], v[64:79]
    v_and_b32 v195, 15, v255
    v_lshrrev_b32 v195, 2, v195
    v_mfma_f32_32x32x16_bf16 v[80:95], a[212:215], a[180:183], v[80:95]
    v_add_u32 v207, v207, v195
    v_mul_u32_u24 v207, 0xe0, v207
    s_waitcnt lgkmcnt(3)
    v_mfma_f32_32x32x16_bf16 v[48:63], a[216:219], a[56:59], v[48:63]
    ds_read_b128 a[200:203], v220 offset:4096
    v_add_u32 v207, s32, v207
    v_and_b32 v195, 15, v255
    v_mfma_f32_32x32x16_bf16 v[64:79], a[216:219], a[120:123], v[64:79]
    v_and_b32 v195, 3, v195
    v_lshlrev_b32 v195, 3, v195
    v_mfma_f32_32x32x16_bf16 v[80:95], a[216:219], a[184:187], v[80:95]
    v_add_u32 v207, v207, v195
    v_and_b32 v208, 15, v255
    s_waitcnt lgkmcnt(3)
    v_mfma_f32_32x32x16_bf16 v[48:63], a[220:223], a[60:63], v[48:63]
    ds_read_b128 a[204:207], v221 offset:4096
    v_lshlrev_b32 v208, 9, v208
    v_lshrrev_b32 v195, 4, v255
    v_mfma_f32_32x32x16_bf16 v[64:79], a[220:223], a[124:127], v[64:79]
    v_and_b32 v194, 15, v255
    v_xor_b32 v195, v195, v194
    v_mfma_f32_32x32x16_bf16 v[80:95], a[220:223], a[188:191], v[80:95]
    v_lshlrev_b32 v195, 4, v195
    v_add_u32 v208, v208, v195
    s_waitcnt lgkmcnt(3)
    v_mfma_f32_32x32x16_bf16 v[96:111], a[192:195], a[0:3], 0
    s_add_u32 m0, s32, 20480
    s_add_u32 s37, s52, 196608
    buffer_load_dwordx4 v214, s[16:19], s37 offen offset:0 nt lds
    s_waitcnt vmcnt(9)
    ds_read_b128 a[208:211], v218 offset:8192
    v_max3_f32 v238, v48, v49, v238
    v_max3_f32 v238, v50, v51, v238
    v_max3_f32 v238, v52, v53, v238
    v_mfma_f32_32x32x16_bf16 v[112:127], a[192:195], a[64:67], 0
    v_max3_f32 v238, v54, v55, v238
    v_max3_f32 v238, v56, v57, v238
    v_max3_f32 v238, v58, v59, v238
    v_mfma_f32_32x32x16_bf16 v[128:143], a[192:195], a[128:131], 0
    v_max3_f32 v238, v60, v61, v238
    v_max3_f32 v238, v62, v63, v238
    v_max3_f32 v239, v64, v65, v239
    s_waitcnt lgkmcnt(3)
    v_mfma_f32_32x32x16_bf16 v[96:111], a[196:199], a[4:7], v[96:111]
    buffer_load_dwordx4 v215, s[16:19], s37 offen offset:1024 nt lds
    ds_read_b128 a[212:215], v219 offset:8192
    v_max3_f32 v239, v66, v67, v239
    v_max3_f32 v239, v68, v69, v239
    v_max3_f32 v239, v70, v71, v239
    v_mfma_f32_32x32x16_bf16 v[112:127], a[196:199], a[68:71], v[112:127]
    v_max3_f32 v239, v72, v73, v239
    v_max3_f32 v239, v74, v75, v239
    v_max3_f32 v239, v76, v77, v239
    v_mfma_f32_32x32x16_bf16 v[128:143], a[196:199], a[132:135], v[128:143]
    v_max3_f32 v239, v78, v79, v239
    v_max3_f32 v240, v80, v81, v240
    v_max3_f32 v240, v82, v83, v240
    s_waitcnt lgkmcnt(3)
    v_mfma_f32_32x32x16_bf16 v[96:111], a[200:203], a[8:11], v[96:111]
    buffer_load_dwordx4 v216, s[16:19], s37 offen offset:2048 nt lds
    ds_read_b128 a[216:219], v220 offset:8192
    v_max3_f32 v240, v84, v85, v240
    v_max3_f32 v240, v86, v87, v240
    v_max3_f32 v240, v88, v89, v240
    v_mfma_f32_32x32x16_bf16 v[112:127], a[200:203], a[72:75], v[112:127]
    v_max3_f32 v240, v90, v91, v240
    v_max3_f32 v240, v92, v93, v240
    v_max3_f32 v240, v94, v95, v240
    v_mfma_f32_32x32x16_bf16 v[128:143], a[200:203], a[136:139], v[128:143]
    v_mov_b32 v250, v238
    v_mov_b32 v251, v239
    v_mov_b32 v252, v240
    s_waitcnt lgkmcnt(3)
    v_mfma_f32_32x32x16_bf16 v[96:111], a[204:207], a[12:15], v[96:111]
    buffer_load_dwordx4 v217, s[16:19], s37 offen offset:3072 nt lds
    ds_read_b128 a[220:223], v221 offset:8192
    v_permlane32_swap_b32 v238, v250
    v_permlane32_swap_b32 v239, v251
    v_permlane32_swap_b32 v240, v252
    v_mfma_f32_32x32x16_bf16 v[112:127], a[204:207], a[76:79], v[112:127]
    v_max_f32 v238, v238, v250
    v_max_f32 v239, v239, v251
    v_max_f32 v240, v240, v252
    v_mfma_f32_32x32x16_bf16 v[128:143], a[204:207], a[140:143], v[128:143]
    ds_write_b32 v236, v238 offset:24576
    ds_write_b32 v236, v239 offset:25088
    ds_write_b32 v236, v240 offset:25600
    s_waitcnt lgkmcnt(6)
    v_mfma_f32_32x32x16_bf16 v[96:111], a[208:211], a[16:19], v[96:111]
    s_add_u32 m0, s32, 24576
    s_add_u32 s37, s52, 196736
    buffer_load_dwordx4 v214, s[16:19], s37 offen offset:0 nt lds
    s_waitcnt vmcnt(9)
    ds_read_b128 a[192:195], v218 offset:12288
    s_waitcnt lgkmcnt(1)
    s_barrier
    ds_read_b128 v[192:195], v237 offset:24576
    v_mfma_f32_32x32x16_bf16 v[112:127], a[208:211], a[80:83], v[112:127]
    ds_read_b128 v[196:199], v237 offset:25088
    ds_read_b128 v[144:147], v237 offset:25600
    s_waitcnt lgkmcnt(2)
    v_max3_f32 v238, v192, v193, v194
    v_mfma_f32_32x32x16_bf16 v[128:143], a[208:211], a[144:147], v[128:143]
    v_max_f32 v238, v238, v195
    v_mul_f32 v241, s33, v238
    v_mov_b32 v244, 0
    v_mfma_f32_32x32x16_bf16 v[96:111], a[212:215], a[20:23], v[96:111]
    buffer_load_dwordx4 v215, s[16:19], s37 offen offset:1024 nt lds
    ds_read_b128 a[196:199], v219 offset:12288
    v_mov_b32 v245, 0
    s_waitcnt lgkmcnt(2)
    v_max3_f32 v239, v196, v197, v198
    v_mfma_f32_32x32x16_bf16 v[112:127], a[212:215], a[84:87], v[112:127]
    v_max_f32 v239, v239, v199
    v_mul_f32 v242, s33, v239
    v_mov_b32 v246, 0
    v_mfma_f32_32x32x16_bf16 v[128:143], a[212:215], a[148:151], v[128:143]
    v_mov_b32 v247, 0
    s_waitcnt lgkmcnt(1)
    v_max3_f32 v240, v144, v145, v146
    v_max_f32 v240, v240, v147
    v_mfma_f32_32x32x16_bf16 v[96:111], a[216:219], a[24:27], v[96:111]
    buffer_load_dwordx4 v216, s[16:19], s37 offen offset:2048 nt lds
    ds_read_b128 a[200:203], v220 offset:12288
    v_mul_f32 v243, s33, v240
    v_mov_b32 v248, 0
    v_mov_b32 v249, 0
    v_mfma_f32_32x32x16_bf16 v[112:127], a[216:219], a[88:91], v[112:127]
    v_fma_f32 v0, v0, s33, -v241
    v_fma_f32 v1, v1, s33, -v241
    v_mfma_f32_32x32x16_bf16 v[128:143], a[216:219], a[152:155], v[128:143]
    v_exp_f32 v0, v0
    v_fma_f32 v2, v2, s33, -v241
    v_exp_f32 v1, v1
    v_mfma_f32_32x32x16_bf16 v[96:111], a[220:223], a[28:31], v[96:111]
    buffer_load_dwordx4 v217, s[16:19], s37 offen offset:3072 nt lds
    ds_read_b128 a[204:207], v221 offset:12288
    v_add_f32 v244, v244, v0
    v_fma_f32 v3, v3, s33, -v241
    v_exp_f32 v2, v2
    v_mfma_f32_32x32x16_bf16 v[112:127], a[220:223], a[92:95], v[112:127]
    v_add_f32 v245, v245, v1
    v_fma_f32 v4, v4, s33, -v241
    v_exp_f32 v3, v3
    v_mfma_f32_32x32x16_bf16 v[128:143], a[220:223], a[156:159], v[128:143]
    v_add_f32 v244, v244, v2
    v_fma_f32 v5, v5, s33, -v241
    v_mfma_f32_32x32x16_bf16 v[96:111], a[192:195], a[32:35], v[96:111]
    s_add_u32 m0, s32, 0
    s_add_u32 s37, s52, 196864
    buffer_load_dwordx4 v214, s[16:19], s37 offen offset:0 nt lds
    s_waitcnt vmcnt(9)
    ds_read_b128 a[208:211], v218 offset:16384
    v_exp_f32 v4, v4
    v_add_f32 v245, v245, v3
    v_fma_f32 v6, v6, s33, -v241
    v_exp_f32 v5, v5
    v_add_f32 v244, v244, v4
    v_mfma_f32_32x32x16_bf16 v[112:127], a[192:195], a[96:99], v[112:127]
    v_fma_f32 v7, v7, s33, -v241
    v_exp_f32 v6, v6
    v_add_f32 v245, v245, v5
    v_exp_f32 v7, v7
    v_mfma_f32_32x32x16_bf16 v[128:143], a[192:195], a[160:163], v[128:143]
    v_add_f32 v244, v244, v6
    v_cvt_pk_bf16_f32 v0, v0, v1
    v_add_f32 v245, v245, v7
    v_cvt_pk_bf16_f32 v1, v2, v3
    v_cvt_pk_bf16_f32 v2, v4, v5
    s_waitcnt lgkmcnt(3)
    v_mfma_f32_32x32x16_bf16 v[96:111], a[196:199], a[36:39], v[96:111]
    buffer_load_dwordx4 v215, s[16:19], s37 offen offset:1024 nt lds
    ds_read_b128 a[212:215], v219 offset:16384
    v_cvt_pk_bf16_f32 v3, v6, v7
    ds_write_b128 v226, v[0:3] offset:0
    v_fma_f32 v8, v8, s33, -v241
    v_fma_f32 v9, v9, s33, -v241
    v_mfma_f32_32x32x16_bf16 v[112:127], a[196:199], a[100:103], v[112:127]
    v_exp_f32 v8, v8
    v_fma_f32 v10, v10, s33, -v241
    v_exp_f32 v9, v9
    v_add_f32 v244, v244, v8
    v_fma_f32 v11, v11, s33, -v241
    v_mfma_f32_32x32x16_bf16 v[128:143], a[196:199], a[164:167], v[128:143]
    v_exp_f32 v10, v10
    v_add_f32 v245, v245, v9
    v_fma_f32 v12, v12, s33, -v241
    v_exp_f32 v11, v11
    s_waitcnt lgkmcnt(4)
    v_mfma_f32_32x32x16_bf16 v[96:111], a[200:203], a[40:43], v[96:111]
    buffer_load_dwordx4 v216, s[16:19], s37 offen offset:2048 nt lds
    ds_read_b128 a[216:219], v220 offset:16384
    v_add_f32 v244, v244, v10
    v_fma_f32 v13, v13, s33, -v241
    v_exp_f32 v12, v12
    v_add_f32 v245, v245, v11
    v_fma_f32 v14, v14, s33, -v241
    v_mfma_f32_32x32x16_bf16 v[112:127], a[200:203], a[104:107], v[112:127]
    v_exp_f32 v13, v13
    v_add_f32 v244, v244, v12
    v_fma_f32 v15, v15, s33, -v241
    v_exp_f32 v14, v14
    v_mfma_f32_32x32x16_bf16 v[128:143], a[200:203], a[168:171], v[128:143]
    v_add_f32 v245, v245, v13
    v_exp_f32 v15, v15
    v_add_f32 v244, v244, v14
    v_cvt_pk_bf16_f32 v8, v8, v9
    v_add_f32 v245, v245, v15
    s_waitcnt lgkmcnt(4)
    v_mfma_f32_32x32x16_bf16 v[96:111], a[204:207], a[44:47], v[96:111]
    buffer_load_dwordx4 v217, s[16:19], s37 offen offset:3072 nt lds
    ds_read_b128 a[220:223], v221 offset:16384
    v_cvt_pk_bf16_f32 v9, v10, v11
    v_cvt_pk_bf16_f32 v10, v12, v13
    v_cvt_pk_bf16_f32 v11, v14, v15
    ds_write_b128 v227, v[8:11] offset:0
    v_mfma_f32_32x32x16_bf16 v[112:127], a[204:207], a[108:111], v[112:127]
    v_fma_f32 v16, v16, s33, -v242
    v_fma_f32 v17, v17, s33, -v242
    v_exp_f32 v16, v16
    v_fma_f32 v18, v18, s33, -v242
    v_exp_f32 v17, v17
    v_mfma_f32_32x32x16_bf16 v[128:143], a[204:207], a[172:175], v[128:143]
    v_add_f32 v246, v246, v16
    v_fma_f32 v19, v19, s33, -v242
    v_exp_f32 v18, v18
    v_add_f32 v247, v247, v17
    s_waitcnt lgkmcnt(5)
    v_mfma_f32_32x32x16_bf16 v[96:111], a[208:211], a[48:51], v[96:111]
    s_add_u32 m0, s32, 4096
    s_add_u32 s37, s52, 196992
    buffer_load_dwordx4 v214, s[16:19], s37 offen offset:0 nt lds
    s_waitcnt vmcnt(9)
    ds_read_b128 a[192:195], v218 offset:20480
    v_fma_f32 v20, v20, s33, -v242
    v_exp_f32 v19, v19
    v_add_f32 v246, v246, v18
    v_fma_f32 v21, v21, s33, -v242
    v_exp_f32 v20, v20
    v_mfma_f32_32x32x16_bf16 v[112:127], a[208:211], a[112:115], v[112:127]
    v_add_f32 v247, v247, v19
    v_fma_f32 v22, v22, s33, -v242
    v_exp_f32 v21, v21
    v_add_f32 v246, v246, v20
    v_fma_f32 v23, v23, s33, -v242
    v_mfma_f32_32x32x16_bf16 v[128:143], a[208:211], a[176:179], v[128:143]
    v_exp_f32 v22, v22
    v_add_f32 v247, v247, v21
    v_exp_f32 v23, v23
    v_add_f32 v246, v246, v22
    s_waitcnt lgkmcnt(5)
    v_mfma_f32_32x32x16_bf16 v[96:111], a[212:215], a[52:55], v[96:111]
    buffer_load_dwordx4 v215, s[16:19], s37 offen offset:1024 nt lds
    ds_read_b128 a[196:199], v219 offset:20480
    v_cvt_pk_bf16_f32 v16, v16, v17
    v_add_f32 v247, v247, v23
    v_cvt_pk_bf16_f32 v17, v18, v19
    v_cvt_pk_bf16_f32 v18, v20, v21
    v_cvt_pk_bf16_f32 v19, v22, v23
    v_mfma_f32_32x32x16_bf16 v[112:127], a[212:215], a[116:119], v[112:127]
    ds_write_b128 v226, v[16:19] offset:8192
    v_fma_f32 v24, v24, s33, -v242
    v_fma_f32 v25, v25, s33, -v242
    v_exp_f32 v24, v24
    v_mfma_f32_32x32x16_bf16 v[128:143], a[212:215], a[180:183], v[128:143]
    v_fma_f32 v26, v26, s33, -v242
    v_exp_f32 v25, v25
    v_add_f32 v246, v246, v24
    v_fma_f32 v27, v27, s33, -v242
    v_exp_f32 v26, v26
    s_waitcnt lgkmcnt(5)
    v_mfma_f32_32x32x16_bf16 v[96:111], a[216:219], a[56:59], v[96:111]
    buffer_load_dwordx4 v216, s[16:19], s37 offen offset:2048 nt lds
    ds_read_b128 a[200:203], v220 offset:20480
    v_add_f32 v247, v247, v25
    v_fma_f32 v28, v28, s33, -v242
    v_exp_f32 v27, v27
    v_add_f32 v246, v246, v26
    v_fma_f32 v29, v29, s33, -v242
    v_mfma_f32_32x32x16_bf16 v[112:127], a[216:219], a[120:123], v[112:127]
    v_exp_f32 v28, v28
    v_add_f32 v247, v247, v27
    v_fma_f32 v30, v30, s33, -v242
    v_exp_f32 v29, v29
    v_mfma_f32_32x32x16_bf16 v[128:143], a[216:219], a[184:187], v[128:143]
    v_add_f32 v246, v246, v28
    v_fma_f32 v31, v31, s33, -v242
    v_exp_f32 v30, v30
    v_add_f32 v247, v247, v29
    v_exp_f32 v31, v31
    s_waitcnt lgkmcnt(5)
    v_mfma_f32_32x32x16_bf16 v[96:111], a[220:223], a[60:63], v[96:111]
    buffer_load_dwordx4 v217, s[16:19], s37 offen offset:3072 nt lds
    ds_read_b128 a[204:207], v221 offset:20480
    v_add_f32 v246, v246, v30
    v_cvt_pk_bf16_f32 v24, v24, v25
    v_add_f32 v247, v247, v31
    v_cvt_pk_bf16_f32 v25, v26, v27
    v_mfma_f32_32x32x16_bf16 v[112:127], a[220:223], a[124:127], v[112:127]
    v_cvt_pk_bf16_f32 v26, v28, v29
    v_cvt_pk_bf16_f32 v27, v30, v31
    ds_write_b128 v227, v[24:27] offset:8192
    v_fma_f32 v32, v32, s33, -v243
    v_fma_f32 v33, v33, s33, -v243
    v_mfma_f32_32x32x16_bf16 v[128:143], a[220:223], a[188:191], v[128:143]
    v_exp_f32 v32, v32
    v_fma_f32 v34, v34, s33, -v243
    v_exp_f32 v33, v33
    v_add_f32 v248, v248, v32
    s_waitcnt lgkmcnt(5)
    v_mfma_f32_32x32x16_bf16 v[144:159], a[192:195], a[0:3], 0
    s_add_u32 m0, s32, 8192
    s_add_u32 s37, s57, 0
    buffer_load_dwordx4 v222, s[20:23], s37 offen offset:0 nt lds
    s_waitcnt vmcnt(9)
    ds_read_b128 a[208:211], v218 offset:24576
    v_fma_f32 v35, v35, s33, -v243
    v_exp_f32 v34, v34
    v_add_f32 v249, v249, v33
    v_fma_f32 v36, v36, s33, -v243
    v_exp_f32 v35, v35
    v_add_f32 v248, v248, v34
    v_mfma_f32_32x32x16_bf16 v[160:175], a[192:195], a[64:67], 0
    v_fma_f32 v37, v37, s33, -v243
    v_exp_f32 v36, v36
    v_add_f32 v249, v249, v35
    v_fma_f32 v38, v38, s33, -v243
    v_exp_f32 v37, v37
    v_mfma_f32_32x32x16_bf16 v[176:191], a[192:195], a[128:131], 0
    v_add_f32 v248, v248, v36
    v_fma_f32 v39, v39, s33, -v243
    v_exp_f32 v38, v38
    v_add_f32 v249, v249, v37
    v_exp_f32 v39, v39
    s_waitcnt lgkmcnt(5)
    v_mfma_f32_32x32x16_bf16 v[144:159], a[196:199], a[4:7], v[144:159]
    buffer_load_dwordx4 v223, s[20:23], s37 offen offset:1024 nt lds
    ds_read_b128 a[212:215], v219 offset:24576
    v_add_f32 v248, v248, v38
    v_cvt_pk_bf16_f32 v32, v32, v33
    v_add_f32 v249, v249, v39
    v_cvt_pk_bf16_f32 v33, v34, v35
    v_cvt_pk_bf16_f32 v34, v36, v37
    v_mfma_f32_32x32x16_bf16 v[160:175], a[196:199], a[68:71], v[160:175]
    v_cvt_pk_bf16_f32 v35, v38, v39
    ds_write_b128 v226, v[32:35] offset:16384
    v_fma_f32 v40, v40, s33, -v243
    v_fma_f32 v41, v41, s33, -v243
    v_exp_f32 v40, v40
    v_mfma_f32_32x32x16_bf16 v[176:191], a[196:199], a[132:135], v[176:191]
    v_fma_f32 v42, v42, s33, -v243
    v_exp_f32 v41, v41
    v_add_f32 v248, v248, v40
    v_fma_f32 v43, v43, s33, -v243
    v_exp_f32 v42, v42
    s_waitcnt lgkmcnt(5)
    v_mfma_f32_32x32x16_bf16 v[144:159], a[200:203], a[8:11], v[144:159]
    buffer_load_dwordx4 v253, s[20:23], s37 offen offset:2048 nt lds
    ds_read_b128 a[216:219], v220 offset:24576
    v_add_f32 v249, v249, v41
    v_fma_f32 v44, v44, s33, -v243
    v_exp_f32 v43, v43
    v_add_f32 v248, v248, v42
    v_fma_f32 v45, v45, s33, -v243
    v_mfma_f32_32x32x16_bf16 v[160:175], a[200:203], a[72:75], v[160:175]
    v_exp_f32 v44, v44
    v_add_f32 v249, v249, v43
    v_fma_f32 v46, v46, s33, -v243
    v_exp_f32 v45, v45
    v_add_f32 v248, v248, v44
    v_mfma_f32_32x32x16_bf16 v[176:191], a[200:203], a[136:139], v[176:191]
    v_fma_f32 v47, v47, s33, -v243
    v_exp_f32 v46, v46
    v_add_f32 v249, v249, v45
    v_exp_f32 v47, v47
    v_add_f32 v248, v248, v46
    s_waitcnt lgkmcnt(5)
    v_mfma_f32_32x32x16_bf16 v[144:159], a[204:207], a[12:15], v[144:159]
    buffer_load_dwordx4 v254, s[20:23], s37 offen offset:3072 nt lds
    ds_read_b128 a[220:223], v221 offset:24576
    v_cvt_pk_bf16_f32 v40, v40, v41
    v_add_f32 v249, v249, v47
    v_cvt_pk_bf16_f32 v41, v42, v43
    v_cvt_pk_bf16_f32 v42, v44, v45
    v_cvt_pk_bf16_f32 v43, v46, v47
    v_mfma_f32_32x32x16_bf16 v[160:175], a[204:207], a[76:79], v[160:175]
    ds_write_b128 v227, v[40:43] offset:16384
    v_fma_f32 v48, v48, s33, -v241
    v_fma_f32 v49, v49, s33, -v241
    v_exp_f32 v48, v48
    v_max_f32 v238, v96, v97
    v_mfma_f32_32x32x16_bf16 v[176:191], a[204:207], a[140:143], v[176:191]
    v_max3_f32 v238, v98, v99, v238
    v_max3_f32 v238, v100, v101, v238
    v_max3_f32 v238, v102, v103, v238
    v_max3_f32 v238, v104, v105, v238
    v_max3_f32 v238, v106, v107, v238
    s_waitcnt lgkmcnt(5)
    v_mfma_f32_32x32x16_bf16 v[144:159], a[208:211], a[16:19], v[144:159]
    s_add_u32 m0, s32, 12288
    s_add_u32 s37, s57, 16384
    buffer_load_dwordx4 v222, s[20:23], s37 offen offset:0 nt lds
    s_waitcnt vmcnt(9)
    ds_read_b128 a[192:195], v218 offset:0
    v_fma_f32 v50, v50, s33, -v241
    v_exp_f32 v49, v49
    v_add_f32 v244, v244, v48
    v_fma_f32 v51, v51, s33, -v241
    v_exp_f32 v50, v50
    v_add_f32 v245, v245, v49
    v_mfma_f32_32x32x16_bf16 v[160:175], a[208:211], a[80:83], v[160:175]
    v_fma_f32 v52, v52, s33, -v241
    v_exp_f32 v51, v51
    v_add_f32 v244, v244, v50
    v_fma_f32 v53, v53, s33, -v241
    v_exp_f32 v52, v52
    v_mfma_f32_32x32x16_bf16 v[176:191], a[208:211], a[144:147], v[176:191]
    v_add_f32 v245, v245, v51
    v_fma_f32 v54, v54, s33, -v241
    v_exp_f32 v53, v53
    v_add_f32 v244, v244, v52
    v_fma_f32 v55, v55, s33, -v241
    s_waitcnt lgkmcnt(5)
    v_mfma_f32_32x32x16_bf16 v[144:159], a[212:215], a[20:23], v[144:159]
    buffer_load_dwordx4 v223, s[20:23], s37 offen offset:1024 nt lds
    ds_read_b128 a[196:199], v219 offset:0
    v_exp_f32 v54, v54
    v_add_f32 v245, v245, v53
    v_exp_f32 v55, v55
    v_add_f32 v244, v244, v54
    v_cvt_pk_bf16_f32 v48, v48, v49
    v_mfma_f32_32x32x16_bf16 v[160:175], a[212:215], a[84:87], v[160:175]
    v_add_f32 v245, v245, v55
    v_cvt_pk_bf16_f32 v49, v50, v51
    v_cvt_pk_bf16_f32 v50, v52, v53
    v_cvt_pk_bf16_f32 v51, v54, v55
    v_fma_f32 v56, v56, s33, -v241
    v_mfma_f32_32x32x16_bf16 v[176:191], a[212:215], a[148:151], v[176:191]
    v_fma_f32 v57, v57, s33, -v241
    v_exp_f32 v56, v56
    v_fma_f32 v58, v58, s33, -v241
    v_exp_f32 v57, v57
    v_add_f32 v244, v244, v56
    s_waitcnt lgkmcnt(4)
    v_mfma_f32_32x32x16_bf16 v[144:159], a[216:219], a[24:27], v[144:159]
    buffer_load_dwordx4 v253, s[20:23], s37 offen offset:2048 nt lds
    ds_read_b128 a[200:203], v220 offset:0
    v_fma_f32 v59, v59, s33, -v241
    v_exp_f32 v58, v58
    v_add_f32 v245, v245, v57
    v_fma_f32 v60, v60, s33, -v241
    v_exp_f32 v59, v59
    v_mfma_f32_32x32x16_bf16 v[160:175], a[216:219], a[88:91], v[160:175]
    v_add_f32 v244, v244, v58
    v_fma_f32 v61, v61, s33, -v241
    v_exp_f32 v60, v60
    v_add_f32 v245, v245, v59
    v_fma_f32 v62, v62, s33, -v241
    v_mfma_f32_32x32x16_bf16 v[176:191], a[216:219], a[152:155], v[176:191]
    v_exp_f32 v61, v61
    v_add_f32 v244, v244, v60
    v_fma_f32 v63, v63, s33, -v241
    v_exp_f32 v62, v62
    v_add_f32 v245, v245, v61
    s_waitcnt lgkmcnt(4)
    v_mfma_f32_32x32x16_bf16 v[144:159], a[220:223], a[28:31], v[144:159]
    buffer_load_dwordx4 v254, s[20:23], s37 offen offset:3072 nt lds
    ds_read_b128 a[204:207], v221 offset:0
    v_exp_f32 v63, v63
    v_add_f32 v244, v244, v62
    v_cvt_pk_bf16_f32 v56, v56, v57
    v_add_f32 v245, v245, v63
    v_cvt_pk_bf16_f32 v57, v58, v59
    v_mfma_f32_32x32x16_bf16 v[160:175], a[220:223], a[92:95], v[160:175]
    v_cvt_pk_bf16_f32 v58, v60, v61
    v_cvt_pk_bf16_f32 v59, v62, v63
    v_fma_f32 v64, v64, s33, -v242
    v_fma_f32 v65, v65, s33, -v242
    v_max3_f32 v238, v108, v109, v238
    v_mfma_f32_32x32x16_bf16 v[176:191], a[220:223], a[156:159], v[176:191]
    v_max3_f32 v238, v110, v111, v238
    v_max_f32 v239, v112, v113
    v_max3_f32 v239, v114, v115, v239
    v_max3_f32 v239, v116, v117, v239
    v_max3_f32 v239, v118, v119, v239
    s_waitcnt lgkmcnt(3)
    v_mfma_f32_32x32x16_bf16 v[144:159], a[192:195], a[32:35], v[144:159]
    s_add_u32 m0, s32, 16384
    s_add_u32 s37, s57, 32768
    buffer_load_dwordx4 v222, s[20:23], s37 offen offset:0 nt lds
    s_waitcnt vmcnt(9)
    ds_read_b128 a[208:211], v218 offset:4096
    v_exp_f32 v64, v64
    v_fma_f32 v66, v66, s33, -v242
    v_exp_f32 v65, v65
    v_add_f32 v246, v246, v64
    v_fma_f32 v67, v67, s33, -v242
    v_exp_f32 v66, v66
    v_mfma_f32_32x32x16_bf16 v[160:175], a[192:195], a[96:99], v[160:175]
    v_add_f32 v247, v247, v65
    v_fma_f32 v68, v68, s33, -v242
    v_exp_f32 v67, v67
    v_add_f32 v246, v246, v66
    v_fma_f32 v69, v69, s33, -v242
    v_mfma_f32_32x32x16_bf16 v[176:191], a[192:195], a[160:163], v[176:191]
    v_exp_f32 v68, v68
    v_add_f32 v247, v247, v67
    v_fma_f32 v70, v70, s33, -v242
    v_exp_f32 v69, v69
    v_add_f32 v246, v246, v68
    s_waitcnt lgkmcnt(3)
    v_mfma_f32_32x32x16_bf16 v[144:159], a[196:199], a[36:39], v[144:159]
    buffer_load_dwordx4 v223, s[20:23], s37 offen offset:1024 nt lds
    ds_read_b128 a[212:215], v219 offset:4096
    v_fma_f32 v71, v71, s33, -v242
    v_exp_f32 v70, v70
    v_add_f32 v247, v247, v69
    v_exp_f32 v71, v71
    v_add_f32 v246, v246, v70
    v_mfma_f32_32x32x16_bf16 v[160:175], a[196:199], a[100:103], v[160:175]
    v_cvt_pk_bf16_f32 v64, v64, v65
    v_add_f32 v247, v247, v71
    v_cvt_pk_bf16_f32 v65, v66, v67
    v_cvt_pk_bf16_f32 v66, v68, v69
    v_cvt_pk_bf16_f32 v67, v70, v71
    v_mfma_f32_32x32x16_bf16 v[176:191], a[196:199], a[164:167], v[176:191]
    v_fma_f32 v72, v72, s33, -v242
    v_fma_f32 v73, v73, s33, -v242
    v_exp_f32 v72, v72
    v_fma_f32 v74, v74, s33, -v242
    v_exp_f32 v73, v73
    s_waitcnt lgkmcnt(3)
    v_mfma_f32_32x32x16_bf16 v[144:159], a[200:203], a[40:43], v[144:159]
    buffer_load_dwordx4 v253, s[20:23], s37 offen offset:2048 nt lds
    ds_read_b128 a[216:219], v220 offset:4096
    v_add_f32 v246, v246, v72
    v_fma_f32 v75, v75, s33, -v242
    v_exp_f32 v74, v74
    v_add_f32 v247, v247, v73
    v_fma_f32 v76, v76, s33, -v242
    v_mfma_f32_32x32x16_bf16 v[160:175], a[200:203], a[104:107], v[160:175]
    v_exp_f32 v75, v75
    v_add_f32 v246, v246, v74
    v_fma_f32 v77, v77, s33, -v242
    v_exp_f32 v76, v76
    v_add_f32 v247, v247, v75
    v_mfma_f32_32x32x16_bf16 v[176:191], a[200:203], a[168:171], v[176:191]
    v_fma_f32 v78, v78, s33, -v242
    v_exp_f32 v77, v77
    v_add_f32 v246, v246, v76
    v_fma_f32 v79, v79, s33, -v242
    v_exp_f32 v78, v78
    s_waitcnt lgkmcnt(3)
    v_mfma_f32_32x32x16_bf16 v[144:159], a[204:207], a[44:47], v[144:159]
    buffer_load_dwordx4 v254, s[20:23], s37 offen offset:3072 nt lds
    ds_read_b128 a[220:223], v221 offset:4096
    v_add_f32 v247, v247, v77
    v_exp_f32 v79, v79
    v_add_f32 v246, v246, v78
    v_cvt_pk_bf16_f32 v72, v72, v73
    v_add_f32 v247, v247, v79
    v_mfma_f32_32x32x16_bf16 v[160:175], a[204:207], a[108:111], v[160:175]
    v_cvt_pk_bf16_f32 v73, v74, v75
    v_cvt_pk_bf16_f32 v74, v76, v77
    v_cvt_pk_bf16_f32 v75, v78, v79
    v_fma_f32 v80, v80, s33, -v243
    v_max3_f32 v239, v120, v121, v239
    v_mfma_f32_32x32x16_bf16 v[176:191], a[204:207], a[172:175], v[176:191]
    v_max3_f32 v239, v122, v123, v239
    v_max3_f32 v239, v124, v125, v239
    v_max3_f32 v239, v126, v127, v239
    v_max_f32 v240, v128, v129
    v_max3_f32 v240, v130, v131, v240
    s_waitcnt lgkmcnt(3)
    v_mfma_f32_32x32x16_bf16 v[144:159], a[208:211], a[48:51], v[144:159]
    s_add_u32 m0, s32, 20480
    s_add_u32 s37, s57, 49152
    buffer_load_dwordx4 v222, s[20:23], s37 offen offset:0 nt lds
    v_fma_f32 v81, v81, s33, -v243
    v_exp_f32 v80, v80
    v_fma_f32 v82, v82, s33, -v243
    v_exp_f32 v81, v81
    v_add_f32 v248, v248, v80
    v_fma_f32 v83, v83, s33, -v243
    v_mfma_f32_32x32x16_bf16 v[160:175], a[208:211], a[112:115], v[160:175]
    v_exp_f32 v82, v82
    v_add_f32 v249, v249, v81
    v_fma_f32 v84, v84, s33, -v243
    v_exp_f32 v83, v83
    v_add_f32 v248, v248, v82
    v_mfma_f32_32x32x16_bf16 v[176:191], a[208:211], a[176:179], v[176:191]
    v_fma_f32 v85, v85, s33, -v243
    v_exp_f32 v84, v84
    v_add_f32 v249, v249, v83
    v_fma_f32 v86, v86, s33, -v243
    v_exp_f32 v85, v85
    s_waitcnt lgkmcnt(2)
    v_mfma_f32_32x32x16_bf16 v[144:159], a[212:215], a[52:55], v[144:159]
    buffer_load_dwordx4 v223, s[20:23], s37 offen offset:1024 nt lds
    v_add_f32 v248, v248, v84
    v_fma_f32 v87, v87, s33, -v243
    v_exp_f32 v86, v86
    v_add_f32 v249, v249, v85
    v_exp_f32 v87, v87
    v_mfma_f32_32x32x16_bf16 v[160:175], a[212:215], a[116:119], v[160:175]
    v_add_f32 v248, v248, v86
    v_cvt_pk_bf16_f32 v80, v80, v81
    v_add_f32 v249, v249, v87
    v_cvt_pk_bf16_f32 v81, v82, v83
    v_cvt_pk_bf16_f32 v82, v84, v85
    v_mfma_f32_32x32x16_bf16 v[176:191], a[212:215], a[180:183], v[176:191]
    v_cvt_pk_bf16_f32 v83, v86, v87
    v_fma_f32 v88, v88, s33, -v243
    v_fma_f32 v89, v89, s33, -v243
    v_exp_f32 v88, v88
    v_fma_f32 v90, v90, s33, -v243
    s_waitcnt lgkmcnt(1)
    v_mfma_f32_32x32x16_bf16 v[144:159], a[216:219], a[56:59], v[144:159]
    buffer_load_dwordx4 v253, s[20:23], s37 offen offset:2048 nt lds
    v_exp_f32 v89, v89
    v_add_f32 v248, v248, v88
    v_fma_f32 v91, v91, s33, -v243
    v_exp_f32 v90, v90
    v_add_f32 v249, v249, v89
    v_mfma_f32_32x32x16_bf16 v[160:175], a[216:219], a[120:123], v[160:175]
    v_fma_f32 v92, v92, s33, -v243
    v_exp_f32 v91, v91
    v_add_f32 v248, v248, v90
    v_fma_f32 v93, v93, s33, -v243
    v_exp_f32 v92, v92
    v_mfma_f32_32x32x16_bf16 v[176:191], a[216:219], a[184:187], v[176:191]
    v_add_f32 v249, v249, v91
    v_fma_f32 v94, v94, s33, -v243
    v_exp_f32 v93, v93
    v_add_f32 v248, v248, v92
    v_fma_f32 v95, v95, s33, -v243
    s_waitcnt lgkmcnt(0)
    v_mfma_f32_32x32x16_bf16 v[144:159], a[220:223], a[60:63], v[144:159]
    buffer_load_dwordx4 v254, s[20:23], s37 offen offset:3072 nt lds
    v_exp_f32 v94, v94
    v_add_f32 v249, v249, v93
    v_exp_f32 v95, v95
    v_add_f32 v248, v248, v94
    v_cvt_pk_bf16_f32 v88, v88, v89
    v_mfma_f32_32x32x16_bf16 v[160:175], a[220:223], a[124:127], v[160:175]
    v_add_f32 v249, v249, v95
    v_cvt_pk_bf16_f32 v89, v90, v91
    v_cvt_pk_bf16_f32 v90, v92, v93
    v_cvt_pk_bf16_f32 v91, v94, v95
    v_max3_f32 v240, v132, v133, v240
    v_mfma_f32_32x32x16_bf16 v[176:191], a[220:223], a[188:191], v[176:191]
    v_max3_f32 v240, v134, v135, v240
    v_max3_f32 v240, v136, v137, v240
    v_max3_f32 v240, v138, v139, v240
    v_max3_f32 v240, v140, v141, v240
    v_max3_f32 v240, v142, v143, v240
    v_max3_f32 v238, v144, v145, v238
    v_max3_f32 v238, v146, v147, v238
    v_max3_f32 v238, v148, v149, v238
    v_max3_f32 v238, v150, v151, v238
    v_max3_f32 v238, v152, v153, v238
    v_max3_f32 v238, v154, v155, v238
    v_max3_f32 v238, v156, v157, v238
    v_max3_f32 v238, v158, v159, v238
    v_max3_f32 v239, v160, v161, v239
    v_max3_f32 v239, v162, v163, v239
    v_max3_f32 v239, v164, v165, v239
    v_max3_f32 v239, v166, v167, v239
    v_max3_f32 v239, v168, v169, v239
    v_max3_f32 v239, v170, v171, v239
    v_max3_f32 v239, v172, v173, v239
    v_max3_f32 v239, v174, v175, v239
    v_max3_f32 v240, v176, v177, v240
    v_max3_f32 v240, v178, v179, v240
    v_max3_f32 v240, v180, v181, v240
    v_max3_f32 v240, v182, v183, v240
    v_max3_f32 v240, v184, v185, v240
    v_max3_f32 v240, v186, v187, v240
    v_max3_f32 v240, v188, v189, v240
    v_max3_f32 v240, v190, v191, v240
    v_mov_b32 v250, v238
    v_mov_b32 v251, v239
    v_mov_b32 v252, v240
    v_permlane32_swap_b32 v238, v250
    v_permlane32_swap_b32 v239, v251
    v_permlane32_swap_b32 v240, v252
    v_max_f32 v238, v238, v250
    v_max_f32 v239, v239, v251
    v_max_f32 v240, v240, v252
    ds_write_b32 v236, v238 offset:26624
    ds_write_b32 v236, v239 offset:27136
    ds_write_b32 v236, v240 offset:27648
    s_waitcnt lgkmcnt(0)
    s_barrier
    ds_read_b128 v[192:195], v237 offset:26624
    ds_read_b128 v[196:199], v237 offset:27136
    ds_read_b128 v[218:221], v237 offset:27648
    s_add_u32 m0, s32, 24576
    s_add_u32 s37, s53, 65536
    buffer_load_dwordx4 v222, s[20:23], s37 offen offset:0 nt lds
    buffer_load_dwordx4 v223, s[20:23], s37 offen offset:1024 nt lds
    buffer_load_dwordx4 v253, s[20:23], s37 offen offset:2048 nt lds
    buffer_load_dwordx4 v254, s[20:23], s37 offen offset:3072 nt lds
    s_waitcnt lgkmcnt(2)
    v_max3_f32 v238, v192, v193, v194
    v_max_f32 v238, v238, v195
    v_fma_f32 v250, v238, s33, -v241
    s_waitcnt lgkmcnt(1)
    v_max3_f32 v239, v196, v197, v198
    v_max_f32 v239, v239, v199
    v_fma_f32 v251, v239, s33, -v242
    s_waitcnt lgkmcnt(0)
    v_max3_f32 v240, v218, v219, v220
    v_max_f32 v240, v240, v221
    v_fma_f32 v252, v240, s33, -v243
    v_max3_f32 v192, v250, v251, v252
    v_cmp_lt_f32 vcc, 0x41200000, v192
    s_nop 3
    s_cbranch_vccnz L_rescale
L_rescale_done:
    s_and_b32 s59, s6, 1
    s_mul_i32 s58, s59, 114688
    s_mul_i32 s38, s3, 224
    s_add_u32 s58, s58, s38
    s_mov_b32 s101, s58
    s_waitcnt vmcnt(18)
    ds_read_b64_tr_b16 a[96:97], v224 offset:8192
    ds_read_b64_tr_b16 a[98:99], v224 offset:9216
    ds_read_b64_tr_b16 a[100:101], v225 offset:8192
    ds_read_b64_tr_b16 a[102:103], v225 offset:9216
    s_waitcnt vmcnt(16)
    ds_read_b64_tr_b16 a[104:105], v224 offset:10240
    ds_read_b64_tr_b16 a[106:107], v224 offset:11264
    ds_read_b64_tr_b16 a[108:109], v225 offset:10240
    ds_read_b64_tr_b16 a[110:111], v225 offset:11264
    s_barrier
    ds_read_b128 a[128:131], v228 offset:0
    ds_read_b128 a[132:135], v228 offset:8192
    ds_read_b128 a[136:139], v228 offset:16384
    ds_read_b128 a[140:143], v229 offset:0
    ds_read_b128 a[144:147], v229 offset:8192
    ds_read_b128 a[148:151], v229 offset:16384
    s_waitcnt lgkmcnt(5)
    v_mfma_f32_32x32x16_bf16 v[0:15], a[96:99], a[128:131], 0
    s_add_u32 m0, s32, 0
    s_add_u32 s37, s53, 81920
    buffer_load_dwordx4 v222, s[20:23], s37 offen offset:0 nt lds
    ds_read_b128 a[152:155], v230 offset:0
    ds_read_b128 a[156:159], v230 offset:8192
    ds_write_b128 v226, v[48:51] offset:24576
    v_fma_f32 v96, v96, s33, -v241
    v_fma_f32 v97, v97, s33, -v241
    v_exp_f32 v96, v96
    s_waitcnt lgkmcnt(7)
    v_mfma_f32_32x32x16_bf16 v[16:31], a[96:99], a[132:135], 0
    ds_read_b128 a[160:163], v230 offset:16384
    v_fma_f32 v98, v98, s33, -v241
    v_exp_f32 v97, v97
    v_add_f32 v244, v244, v96
    s_waitcnt lgkmcnt(7)
    v_mfma_f32_32x32x16_bf16 v[32:47], a[96:99], a[136:139], 0
    s_waitcnt vmcnt(15)
    ds_read_b64_tr_b16 a[112:113], v224 offset:12288
    v_fma_f32 v99, v99, s33, -v241
    v_exp_f32 v98, v98
    v_add_f32 v245, v245, v97
    v_fma_f32 v100, v100, s33, -v241
    v_mfma_f32_32x32x16_bf16 a[48:63], a[100:103], a[128:131], 0
    buffer_load_dwordx4 v223, s[20:23], s37 offen offset:1024 nt lds
    ds_read_b64_tr_b16 a[114:115], v224 offset:13312
    v_exp_f32 v99, v99
    v_add_f32 v244, v244, v98
    v_fma_f32 v101, v101, s33, -v241
    v_mfma_f32_32x32x16_bf16 a[64:79], a[100:103], a[132:135], 0
    ds_read_b64_tr_b16 a[116:117], v225 offset:12288
    v_exp_f32 v100, v100
    v_add_f32 v245, v245, v99
    v_fma_f32 v102, v102, s33, -v241
    v_exp_f32 v101, v101
    v_mfma_f32_32x32x16_bf16 a[80:95], a[100:103], a[136:139], 0
    ds_read_b64_tr_b16 a[118:119], v225 offset:13312
    v_add_f32 v244, v244, v100
    v_fma_f32 v103, v103, s33, -v241
    v_exp_f32 v102, v102
    s_waitcnt lgkmcnt(10)
    v_mfma_f32_32x32x16_bf16 v[0:15], a[104:107], a[140:143], v[0:15]
    s_add_u32 m0, s32, 0
    s_add_u32 s37, s53, 81920
    buffer_load_dwordx4 v253, s[20:23], s37 offen offset:2048 nt lds
    ds_read_b128 a[128:131], v231 offset:0
    ds_read_b128 a[132:135], v231 offset:8192
    v_add_f32 v245, v245, v101
    v_exp_f32 v103, v103
    v_add_f32 v244, v244, v102
    v_cvt_pk_bf16_f32 v96, v96, v97
    s_waitcnt lgkmcnt(11)
    v_mfma_f32_32x32x16_bf16 v[16:31], a[104:107], a[144:147], v[16:31]
    ds_read_b128 a[136:139], v231 offset:16384
    v_add_f32 v245, v245, v103
    v_cvt_pk_bf16_f32 v97, v98, v99
    v_cvt_pk_bf16_f32 v98, v100, v101
    v_cvt_pk_bf16_f32 v99, v102, v103
    s_waitcnt lgkmcnt(11)
    v_mfma_f32_32x32x16_bf16 v[32:47], a[104:107], a[148:151], v[32:47]
    s_waitcnt vmcnt(15)
    ds_read_b64_tr_b16 a[96:97], v224 offset:14336
    ds_write_b128 v227, v[56:59] offset:24576
    v_fma_f32 v104, v104, s33, -v241
    v_fma_f32 v105, v105, s33, -v241
    v_mfma_f32_32x32x16_bf16 a[48:63], a[108:111], a[140:143], a[48:63]
    buffer_load_dwordx4 v254, s[20:23], s37 offen offset:3072 nt lds
    ds_read_b64_tr_b16 a[98:99], v224 offset:15360
    v_exp_f32 v104, v104
    v_fma_f32 v106, v106, s33, -v241
    v_exp_f32 v105, v105
    v_add_f32 v244, v244, v104
    v_mfma_f32_32x32x16_bf16 a[64:79], a[108:111], a[144:147], a[64:79]
    ds_read_b64_tr_b16 a[100:101], v225 offset:14336
    v_fma_f32 v107, v107, s33, -v241
    v_exp_f32 v106, v106
    v_add_f32 v245, v245, v105
    v_fma_f32 v108, v108, s33, -v241
    v_mfma_f32_32x32x16_bf16 a[80:95], a[108:111], a[148:151], a[80:95]
    ds_read_b64_tr_b16 a[102:103], v225 offset:15360
    v_exp_f32 v107, v107
    v_add_f32 v244, v244, v106
    v_fma_f32 v109, v109, s33, -v241
    s_waitcnt lgkmcnt(10)
    v_mfma_f32_32x32x16_bf16 v[0:15], a[112:115], a[152:155], v[0:15]
    s_add_u32 m0, s32, 4096
    s_add_u32 s37, s53, 98304
    buffer_load_dwordx4 v222, s[20:23], s37 offen offset:0 nt lds
    ds_read_b128 a[140:143], v232 offset:0
    ds_read_b128 a[144:147], v232 offset:8192
    v_exp_f32 v108, v108
    v_add_f32 v245, v245, v107
    v_fma_f32 v110, v110, s33, -v241
    v_exp_f32 v109, v109
    v_mfma_f32_32x32x16_bf16 v[16:31], a[112:115], a[156:159], v[16:31]
    ds_read_b128 a[148:151], v232 offset:16384
    v_add_f32 v244, v244, v108
    v_fma_f32 v111, v111, s33, -v241
    v_exp_f32 v110, v110
    v_add_f32 v245, v245, v109
    v_mfma_f32_32x32x16_bf16 v[32:47], a[112:115], a[160:163], v[32:47]
    s_waitcnt vmcnt(15)
    ds_read_b64_tr_b16 a[104:105], v224 offset:16384
    v_exp_f32 v111, v111
    v_add_f32 v244, v244, v110
    v_cvt_pk_bf16_f32 v104, v104, v105
    s_waitcnt lgkmcnt(12)
    v_mfma_f32_32x32x16_bf16 a[48:63], a[116:119], a[152:155], a[48:63]
    buffer_load_dwordx4 v223, s[20:23], s37 offen offset:1024 nt lds
    ds_read_b64_tr_b16 a[106:107], v224 offset:17408
    v_add_f32 v245, v245, v111
    v_cvt_pk_bf16_f32 v105, v106, v107
    v_cvt_pk_bf16_f32 v106, v108, v109
    v_cvt_pk_bf16_f32 v107, v110, v111
    v_mfma_f32_32x32x16_bf16 a[64:79], a[116:119], a[156:159], a[64:79]
    ds_read_b64_tr_b16 a[108:109], v225 offset:16384
    ds_write_b128 v226, v[64:67] offset:32768
    v_fma_f32 v112, v112, s33, -v242
    v_fma_f32 v113, v113, s33, -v242
    v_exp_f32 v112, v112
    v_mfma_f32_32x32x16_bf16 a[80:95], a[116:119], a[160:163], a[80:95]
    ds_read_b64_tr_b16 a[110:111], v225 offset:17408
    v_fma_f32 v114, v114, s33, -v242
    v_exp_f32 v113, v113
    v_add_f32 v246, v246, v112
    s_waitcnt lgkmcnt(10)
    v_mfma_f32_32x32x16_bf16 v[0:15], a[96:99], a[128:131], v[0:15]
    s_add_u32 m0, s32, 4096
    s_add_u32 s37, s53, 98304
    buffer_load_dwordx4 v253, s[20:23], s37 offen offset:2048 nt lds
    ds_read_b128 a[152:155], v233 offset:0
    ds_read_b128 a[156:159], v233 offset:8192
    v_fma_f32 v115, v115, s33, -v242
    v_exp_f32 v114, v114
    v_add_f32 v247, v247, v113
    v_fma_f32 v116, v116, s33, -v242
    v_mfma_f32_32x32x16_bf16 v[16:31], a[96:99], a[132:135], v[16:31]
    ds_read_b128 a[160:163], v233 offset:16384
    v_exp_f32 v115, v115
    v_add_f32 v246, v246, v114
    v_fma_f32 v117, v117, s33, -v242
    v_exp_f32 v116, v116
    v_mfma_f32_32x32x16_bf16 v[32:47], a[96:99], a[136:139], v[32:47]
    s_waitcnt vmcnt(15)
    ds_read_b64_tr_b16 a[112:113], v224 offset:18432
    v_add_f32 v247, v247, v115
    v_fma_f32 v118, v118, s33, -v242
    v_exp_f32 v117, v117
    s_waitcnt lgkmcnt(12)
    v_mfma_f32_32x32x16_bf16 a[48:63], a[100:103], a[128:131], a[48:63]
    buffer_load_dwordx4 v254, s[20:23], s37 offen offset:3072 nt lds
    ds_read_b64_tr_b16 a[114:115], v224 offset:19456
    v_add_f32 v246, v246, v116
    v_fma_f32 v119, v119, s33, -v242
    v_exp_f32 v118, v118
    v_add_f32 v247, v247, v117
    v_mfma_f32_32x32x16_bf16 a[64:79], a[100:103], a[132:135], a[64:79]
    ds_read_b64_tr_b16 a[116:117], v225 offset:18432
    v_exp_f32 v119, v119
    v_add_f32 v246, v246, v118
    v_cvt_pk_bf16_f32 v112, v112, v113
    v_add_f32 v247, v247, v119
    v_mfma_f32_32x32x16_bf16 a[80:95], a[100:103], a[136:139], a[80:95]
    ds_read_b64_tr_b16 a[118:119], v225 offset:19456
    v_cvt_pk_bf16_f32 v113, v114, v115
    v_cvt_pk_bf16_f32 v114, v116, v117
    v_cvt_pk_bf16_f32 v115, v118, v119
    s_waitcnt lgkmcnt(10)
    v_mfma_f32_32x32x16_bf16 v[0:15], a[104:107], a[140:143], v[0:15]
    s_add_u32 m0, s32, 8192
    s_add_u32 s37, s53, 114688
    buffer_load_dwordx4 v222, s[20:23], s37 offen offset:0 nt lds
    ds_read_b128 a[128:131], v234 offset:0
    ds_read_b128 a[132:135], v234 offset:8192
    ds_write_b128 v227, v[72:75] offset:32768
    v_fma_f32 v120, v120, s33, -v242
    v_fma_f32 v121, v121, s33, -v242
    v_exp_f32 v120, v120
    v_mfma_f32_32x32x16_bf16 v[16:31], a[104:107], a[144:147], v[16:31]
    ds_read_b128 a[136:139], v234 offset:16384
    v_fma_f32 v122, v122, s33, -v242
    v_exp_f32 v121, v121
    v_add_f32 v246, v246, v120
    v_mfma_f32_32x32x16_bf16 v[32:47], a[104:107], a[148:151], v[32:47]
    s_waitcnt vmcnt(15)
    ds_read_b64_tr_b16 a[96:97], v224 offset:20480
    v_fma_f32 v123, v123, s33, -v242
    v_exp_f32 v122, v122
    v_add_f32 v247, v247, v121
    v_fma_f32 v124, v124, s33, -v242
    s_waitcnt lgkmcnt(12)
    v_mfma_f32_32x32x16_bf16 a[48:63], a[108:111], a[140:143], a[48:63]
    buffer_load_dwordx4 v223, s[20:23], s37 offen offset:1024 nt lds
    ds_read_b64_tr_b16 a[98:99], v224 offset:21504
    v_exp_f32 v123, v123
    v_add_f32 v246, v246, v122
    v_fma_f32 v125, v125, s33, -v242
    v_mfma_f32_32x32x16_bf16 a[64:79], a[108:111], a[144:147], a[64:79]
    ds_read_b64_tr_b16 a[100:101], v225 offset:20480
    v_exp_f32 v124, v124
    v_add_f32 v247, v247, v123
    v_fma_f32 v126, v126, s33, -v242
    v_exp_f32 v125, v125
    v_mfma_f32_32x32x16_bf16 a[80:95], a[108:111], a[148:151], a[80:95]
    ds_read_b64_tr_b16 a[102:103], v225 offset:21504
    v_add_f32 v246, v246, v124
    v_fma_f32 v127, v127, s33, -v242
    v_exp_f32 v126, v126
    s_waitcnt lgkmcnt(10)
    v_mfma_f32_32x32x16_bf16 v[0:15], a[112:115], a[152:155], v[0:15]
    s_add_u32 m0, s32, 8192
    s_add_u32 s37, s53, 114688
    buffer_load_dwordx4 v253, s[20:23], s37 offen offset:2048 nt lds
    ds_read_b128 a[140:143], v235 offset:0
    ds_read_b128 a[144:147], v235 offset:8192
    v_add_f32 v247, v247, v125
    v_exp_f32 v127, v127
    v_add_f32 v246, v246, v126
    v_cvt_pk_bf16_f32 v120, v120, v121
    v_mfma_f32_32x32x16_bf16 v[16:31], a[112:115], a[156:159], v[16:31]
    ds_read_b128 a[148:151], v235 offset:16384
    v_add_f32 v247, v247, v127
    v_cvt_pk_bf16_f32 v121, v122, v123
    v_cvt_pk_bf16_f32 v122, v124, v125
    v_cvt_pk_bf16_f32 v123, v126, v127
    v_mfma_f32_32x32x16_bf16 v[32:47], a[112:115], a[160:163], v[32:47]
    s_waitcnt vmcnt(15)
    ds_read_b64_tr_b16 a[104:105], v224 offset:22528
    ds_write_b128 v226, v[80:83] offset:40960
    v_fma_f32 v128, v128, s33, -v243
    v_fma_f32 v129, v129, s33, -v243
    s_waitcnt lgkmcnt(13)
    v_mfma_f32_32x32x16_bf16 a[48:63], a[116:119], a[152:155], a[48:63]
    buffer_load_dwordx4 v254, s[20:23], s37 offen offset:3072 nt lds
    ds_read_b64_tr_b16 a[106:107], v224 offset:23552
    v_exp_f32 v128, v128
    v_fma_f32 v130, v130, s33, -v243
    v_exp_f32 v129, v129
    v_add_f32 v248, v248, v128
    v_mfma_f32_32x32x16_bf16 a[64:79], a[116:119], a[156:159], a[64:79]
    ds_read_b64_tr_b16 a[108:109], v225 offset:22528
    v_fma_f32 v131, v131, s33, -v243
    v_exp_f32 v130, v130
    v_add_f32 v249, v249, v129
    v_fma_f32 v132, v132, s33, -v243
    v_mfma_f32_32x32x16_bf16 a[80:95], a[116:119], a[160:163], a[80:95]
    ds_read_b64_tr_b16 a[110:111], v225 offset:23552
    v_exp_f32 v131, v131
    v_add_f32 v248, v248, v130
    v_fma_f32 v133, v133, s33, -v243
    s_waitcnt lgkmcnt(10)
    v_mfma_f32_32x32x16_bf16 v[0:15], a[96:99], a[128:131], v[0:15]
    s_add_u32 m0, s32, 12288
    s_add_u32 s37, s57, 131072
    buffer_load_dwordx4 v222, s[20:23], s37 offen offset:0 nt lds
    s_waitcnt vmcnt(15)
    ds_read_b64_tr_b16 a[112:113], v224 offset:24576
    v_exp_f32 v132, v132
    v_add_f32 v249, v249, v131
    v_fma_f32 v134, v134, s33, -v243
    v_exp_f32 v133, v133
    v_mfma_f32_32x32x16_bf16 v[16:31], a[96:99], a[132:135], v[16:31]
    ds_read_b64_tr_b16 a[114:115], v224 offset:25600
    v_add_f32 v248, v248, v132
    v_fma_f32 v135, v135, s33, -v243
    v_exp_f32 v134, v134
    v_add_f32 v249, v249, v133
    v_mfma_f32_32x32x16_bf16 v[32:47], a[96:99], a[136:139], v[32:47]
    v_exp_f32 v135, v135
    v_add_f32 v248, v248, v134
    v_cvt_pk_bf16_f32 v128, v128, v129
    s_waitcnt lgkmcnt(10)
    v_mfma_f32_32x32x16_bf16 a[48:63], a[100:103], a[128:131], a[48:63]
    buffer_load_dwordx4 v223, s[20:23], s37 offen offset:1024 nt lds
    ds_read_b64_tr_b16 a[116:117], v225 offset:24576
    v_add_f32 v249, v249, v135
    v_cvt_pk_bf16_f32 v129, v130, v131
    v_cvt_pk_bf16_f32 v130, v132, v133
    v_cvt_pk_bf16_f32 v131, v134, v135
    v_mfma_f32_32x32x16_bf16 a[64:79], a[100:103], a[132:135], a[64:79]
    ds_read_b64_tr_b16 a[118:119], v225 offset:25600
    ds_write_b128 v227, v[88:91] offset:40960
    v_fma_f32 v136, v136, s33, -v243
    v_fma_f32 v137, v137, s33, -v243
    v_exp_f32 v136, v136
    v_mfma_f32_32x32x16_bf16 a[80:95], a[100:103], a[136:139], a[80:95]
    v_fma_f32 v138, v138, s33, -v243
    v_exp_f32 v137, v137
    v_add_f32 v248, v248, v136
    s_waitcnt lgkmcnt(7)
    v_mfma_f32_32x32x16_bf16 v[0:15], a[104:107], a[140:143], v[0:15]
    s_add_u32 m0, s32, 12288
    s_add_u32 s37, s57, 131072
    buffer_load_dwordx4 v253, s[20:23], s37 offen offset:2048 nt lds
    s_waitcnt vmcnt(15)
    ds_read_b64_tr_b16 a[96:97], v224 offset:26624
    v_fma_f32 v139, v139, s33, -v243
    v_exp_f32 v138, v138
    v_add_f32 v249, v249, v137
    v_fma_f32 v140, v140, s33, -v243
    v_mfma_f32_32x32x16_bf16 v[16:31], a[104:107], a[144:147], v[16:31]
    ds_read_b64_tr_b16 a[98:99], v224 offset:27648
    v_exp_f32 v139, v139
    v_add_f32 v248, v248, v138
    v_fma_f32 v141, v141, s33, -v243
    v_exp_f32 v140, v140
    v_mfma_f32_32x32x16_bf16 v[32:47], a[104:107], a[148:151], v[32:47]
    v_add_f32 v249, v249, v139
    v_fma_f32 v142, v142, s33, -v243
    v_exp_f32 v141, v141
    s_waitcnt lgkmcnt(7)
    v_mfma_f32_32x32x16_bf16 a[48:63], a[108:111], a[140:143], a[48:63]
    buffer_load_dwordx4 v254, s[20:23], s37 offen offset:3072 nt lds
    ds_read_b64_tr_b16 a[100:101], v225 offset:26624
    v_add_f32 v248, v248, v140
    v_fma_f32 v143, v143, s33, -v243
    v_exp_f32 v142, v142
    v_add_f32 v249, v249, v141
    v_mfma_f32_32x32x16_bf16 a[64:79], a[108:111], a[144:147], a[64:79]
    ds_read_b64_tr_b16 a[102:103], v225 offset:27648
    v_exp_f32 v143, v143
    v_add_f32 v248, v248, v142
    v_cvt_pk_bf16_f32 v136, v136, v137
    v_add_f32 v249, v249, v143
    v_mfma_f32_32x32x16_bf16 a[80:95], a[108:111], a[148:151], a[80:95]
    v_cvt_pk_bf16_f32 v137, v138, v139
    v_cvt_pk_bf16_f32 v138, v140, v141
    v_cvt_pk_bf16_f32 v139, v142, v143
    s_waitcnt lgkmcnt(4)
    s_barrier
    ds_read_b128 a[152:155], v228 offset:24576
    ds_read_b128 a[156:159], v228 offset:32768
    ds_read_b128 a[160:163], v228 offset:40960
    ds_read_b128 a[128:131], v229 offset:24576
    ds_read_b128 a[132:135], v229 offset:32768
    ds_read_b128 a[136:139], v229 offset:40960
    s_waitcnt lgkmcnt(5)
    v_mfma_f32_32x32x16_bf16 v[0:15], a[112:115], a[152:155], v[0:15]
    s_add_u32 m0, s32, 16384
    s_add_u32 s37, s57, 147456
    buffer_load_dwordx4 v222, s[20:23], s37 offen offset:0 nt lds
    ds_read_b128 a[140:143], v230 offset:24576
    ds_read_b128 a[144:147], v230 offset:32768
    ds_write_b128 v226, v[96:99] offset:0
    v_fma_f32 v144, v144, s33, -v241
    v_fma_f32 v145, v145, s33, -v241
    v_exp_f32 v144, v144
    s_waitcnt lgkmcnt(7)
    v_mfma_f32_32x32x16_bf16 v[16:31], a[112:115], a[156:159], v[16:31]
    ds_read_b128 a[148:151], v230 offset:40960
    v_fma_f32 v146, v146, s33, -v241
    v_exp_f32 v145, v145
    v_add_f32 v244, v244, v144
    s_waitcnt lgkmcnt(7)
    v_mfma_f32_32x32x16_bf16 v[32:47], a[112:115], a[160:163], v[32:47]
    s_waitcnt vmcnt(15)
    ds_read_b64_tr_b16 a[104:105], v224 offset:0
    v_fma_f32 v147, v147, s33, -v241
    v_exp_f32 v146, v146
    v_add_f32 v245, v245, v145
    v_fma_f32 v148, v148, s33, -v241
    v_mfma_f32_32x32x16_bf16 a[48:63], a[116:119], a[152:155], a[48:63]
    buffer_load_dwordx4 v223, s[20:23], s37 offen offset:1024 nt lds
    ds_read_b64_tr_b16 a[106:107], v224 offset:1024
    v_exp_f32 v147, v147
    v_add_f32 v244, v244, v146
    v_fma_f32 v149, v149, s33, -v241
    v_mfma_f32_32x32x16_bf16 a[64:79], a[116:119], a[156:159], a[64:79]
    ds_read_b64_tr_b16 a[108:109], v225 offset:0
    v_exp_f32 v148, v148
    v_add_f32 v245, v245, v147
    v_fma_f32 v150, v150, s33, -v241
    v_exp_f32 v149, v149
    v_mfma_f32_32x32x16_bf16 a[80:95], a[116:119], a[160:163], a[80:95]
    ds_read_b64_tr_b16 a[110:111], v225 offset:1024
    v_add_f32 v244, v244, v148
    v_fma_f32 v151, v151, s33, -v241
    v_exp_f32 v150, v150
    s_waitcnt lgkmcnt(10)
    v_mfma_f32_32x32x16_bf16 v[0:15], a[96:99], a[128:131], v[0:15]
    s_add_u32 m0, s32, 16384
    s_add_u32 s37, s57, 147456
    buffer_load_dwordx4 v253, s[20:23], s37 offen offset:2048 nt lds
    ds_read_b128 a[152:155], v231 offset:24576
    ds_read_b128 a[156:159], v231 offset:32768
    v_add_f32 v245, v245, v149
    v_exp_f32 v151, v151
    v_add_f32 v244, v244, v150
    v_cvt_pk_bf16_f32 v144, v144, v145
    s_waitcnt lgkmcnt(11)
    v_mfma_f32_32x32x16_bf16 v[16:31], a[96:99], a[132:135], v[16:31]
    ds_read_b128 a[160:163], v231 offset:40960
    v_add_f32 v245, v245, v151
    v_cvt_pk_bf16_f32 v145, v146, v147
    v_cvt_pk_bf16_f32 v146, v148, v149
    v_cvt_pk_bf16_f32 v147, v150, v151
    s_waitcnt lgkmcnt(11)
    v_mfma_f32_32x32x16_bf16 v[32:47], a[96:99], a[136:139], v[32:47]
    s_waitcnt vmcnt(15)
    ds_read_b64_tr_b16 a[112:113], v224 offset:2048
    ds_write_b128 v227, v[104:107] offset:0
    v_fma_f32 v152, v152, s33, -v241
    v_fma_f32 v153, v153, s33, -v241
    v_mfma_f32_32x32x16_bf16 a[48:63], a[100:103], a[128:131], a[48:63]
    buffer_load_dwordx4 v254, s[20:23], s37 offen offset:3072 nt lds
    ds_read_b64_tr_b16 a[114:115], v224 offset:3072
    v_exp_f32 v152, v152
    v_fma_f32 v154, v154, s33, -v241
    v_exp_f32 v153, v153
    v_add_f32 v244, v244, v152
    v_mfma_f32_32x32x16_bf16 a[64:79], a[100:103], a[132:135], a[64:79]
    ds_read_b64_tr_b16 a[116:117], v225 offset:2048
    v_fma_f32 v155, v155, s33, -v241
    v_exp_f32 v154, v154
    v_add_f32 v245, v245, v153
    v_fma_f32 v156, v156, s33, -v241
    v_mfma_f32_32x32x16_bf16 a[80:95], a[100:103], a[136:139], a[80:95]
    ds_read_b64_tr_b16 a[118:119], v225 offset:3072
    v_exp_f32 v155, v155
    v_add_f32 v244, v244, v154
    v_fma_f32 v157, v157, s33, -v241
    s_waitcnt lgkmcnt(10)
    v_mfma_f32_32x32x16_bf16 v[0:15], a[104:107], a[140:143], v[0:15]
    s_add_u32 m0, s32, 20480
    s_add_u32 s37, s57, 163840
    buffer_load_dwordx4 v222, s[20:23], s37 offen offset:0 nt lds
    ds_read_b128 a[128:131], v232 offset:24576
    ds_read_b128 a[132:135], v232 offset:32768
    v_exp_f32 v156, v156
    v_add_f32 v245, v245, v155
    v_fma_f32 v158, v158, s33, -v241
    v_exp_f32 v157, v157
    v_mfma_f32_32x32x16_bf16 v[16:31], a[104:107], a[144:147], v[16:31]
    ds_read_b128 a[136:139], v232 offset:40960
    v_add_f32 v244, v244, v156
    v_fma_f32 v159, v159, s33, -v241
    v_exp_f32 v158, v158
    v_add_f32 v245, v245, v157
    v_mfma_f32_32x32x16_bf16 v[32:47], a[104:107], a[148:151], v[32:47]
    s_waitcnt vmcnt(15)
    ds_read_b64_tr_b16 a[96:97], v224 offset:4096
    v_exp_f32 v159, v159
    v_add_f32 v244, v244, v158
    v_cvt_pk_bf16_f32 v152, v152, v153
    s_waitcnt lgkmcnt(12)
    v_mfma_f32_32x32x16_bf16 a[48:63], a[108:111], a[140:143], a[48:63]
    buffer_load_dwordx4 v223, s[20:23], s37 offen offset:1024 nt lds
    ds_read_b64_tr_b16 a[98:99], v224 offset:5120
    v_add_f32 v245, v245, v159
    v_cvt_pk_bf16_f32 v153, v154, v155
    v_cvt_pk_bf16_f32 v154, v156, v157
    v_cvt_pk_bf16_f32 v155, v158, v159
    v_mfma_f32_32x32x16_bf16 a[64:79], a[108:111], a[144:147], a[64:79]
    ds_read_b64_tr_b16 a[100:101], v225 offset:4096
    ds_write_b128 v226, v[112:115] offset:8192
    v_fma_f32 v160, v160, s33, -v242
    v_fma_f32 v161, v161, s33, -v242
    v_exp_f32 v160, v160
    v_mfma_f32_32x32x16_bf16 a[80:95], a[108:111], a[148:151], a[80:95]
    ds_read_b64_tr_b16 a[102:103], v225 offset:5120
    v_fma_f32 v162, v162, s33, -v242
    v_exp_f32 v161, v161
    v_add_f32 v246, v246, v160
    s_waitcnt lgkmcnt(10)
    v_mfma_f32_32x32x16_bf16 v[0:15], a[112:115], a[152:155], v[0:15]
    s_add_u32 m0, s32, 20480
    s_add_u32 s37, s57, 163840
    buffer_load_dwordx4 v253, s[20:23], s37 offen offset:2048 nt lds
    ds_read_b128 a[140:143], v233 offset:24576
    ds_read_b128 a[144:147], v233 offset:32768
    v_fma_f32 v163, v163, s33, -v242
    v_exp_f32 v162, v162
    v_add_f32 v247, v247, v161
    v_fma_f32 v164, v164, s33, -v242
    v_mfma_f32_32x32x16_bf16 v[16:31], a[112:115], a[156:159], v[16:31]
    ds_read_b128 a[148:151], v233 offset:40960
    v_exp_f32 v163, v163
    v_add_f32 v246, v246, v162
    v_fma_f32 v165, v165, s33, -v242
    v_exp_f32 v164, v164
    v_mfma_f32_32x32x16_bf16 v[32:47], a[112:115], a[160:163], v[32:47]
    s_waitcnt vmcnt(15)
    ds_read_b64_tr_b16 a[104:105], v224 offset:6144
    v_add_f32 v247, v247, v163
    v_fma_f32 v166, v166, s33, -v242
    v_exp_f32 v165, v165
    s_waitcnt lgkmcnt(12)
    v_mfma_f32_32x32x16_bf16 a[48:63], a[116:119], a[152:155], a[48:63]
    buffer_load_dwordx4 v254, s[20:23], s37 offen offset:3072 nt lds
    ds_read_b64_tr_b16 a[106:107], v224 offset:7168
    v_add_f32 v246, v246, v164
    v_fma_f32 v167, v167, s33, -v242
    v_exp_f32 v166, v166
    v_add_f32 v247, v247, v165
    v_mfma_f32_32x32x16_bf16 a[64:79], a[116:119], a[156:159], a[64:79]
    ds_read_b64_tr_b16 a[108:109], v225 offset:6144
    v_exp_f32 v167, v167
    v_add_f32 v246, v246, v166
    v_cvt_pk_bf16_f32 v160, v160, v161
    v_add_f32 v247, v247, v167
    v_mfma_f32_32x32x16_bf16 a[80:95], a[116:119], a[160:163], a[80:95]
    ds_read_b64_tr_b16 a[110:111], v225 offset:7168
    v_cvt_pk_bf16_f32 v161, v162, v163
    v_cvt_pk_bf16_f32 v162, v164, v165
    v_cvt_pk_bf16_f32 v163, v166, v167
    s_waitcnt lgkmcnt(10)
    v_mfma_f32_32x32x16_bf16 v[0:15], a[96:99], a[128:131], v[0:15]
    s_add_u32 m0, s32, 24576
    s_add_u32 s37, s57, 180224
    buffer_load_dwordx4 v222, s[20:23], s37 offen offset:0 nt lds
    ds_read_b128 a[152:155], v234 offset:24576
    ds_read_b128 a[156:159], v234 offset:32768
    ds_write_b128 v227, v[120:123] offset:8192
    v_fma_f32 v168, v168, s33, -v242
    v_fma_f32 v169, v169, s33, -v242
    v_exp_f32 v168, v168
    v_mfma_f32_32x32x16_bf16 v[16:31], a[96:99], a[132:135], v[16:31]
    ds_read_b128 a[160:163], v234 offset:40960
    v_fma_f32 v170, v170, s33, -v242
    v_exp_f32 v169, v169
    v_add_f32 v246, v246, v168
    v_mfma_f32_32x32x16_bf16 v[32:47], a[96:99], a[136:139], v[32:47]
    s_waitcnt vmcnt(15)
    ds_read_b64_tr_b16 a[112:113], v224 offset:8192
    v_fma_f32 v171, v171, s33, -v242
    v_exp_f32 v170, v170
    v_add_f32 v247, v247, v169
    v_fma_f32 v172, v172, s33, -v242
    s_waitcnt lgkmcnt(12)
    v_mfma_f32_32x32x16_bf16 a[48:63], a[100:103], a[128:131], a[48:63]
    buffer_load_dwordx4 v223, s[20:23], s37 offen offset:1024 nt lds
    ds_read_b64_tr_b16 a[114:115], v224 offset:9216
    v_exp_f32 v171, v171
    v_add_f32 v246, v246, v170
    v_fma_f32 v173, v173, s33, -v242
    v_mfma_f32_32x32x16_bf16 a[64:79], a[100:103], a[132:135], a[64:79]
    ds_read_b64_tr_b16 a[116:117], v225 offset:8192
    v_exp_f32 v172, v172
    v_add_f32 v247, v247, v171
    v_fma_f32 v174, v174, s33, -v242
    v_exp_f32 v173, v173
    v_mfma_f32_32x32x16_bf16 a[80:95], a[100:103], a[136:139], a[80:95]
    ds_read_b64_tr_b16 a[118:119], v225 offset:9216
    v_add_f32 v246, v246, v172
    v_fma_f32 v175, v175, s33, -v242
    v_exp_f32 v174, v174
    s_waitcnt lgkmcnt(10)
    v_mfma_f32_32x32x16_bf16 v[0:15], a[104:107], a[140:143], v[0:15]
    s_add_u32 m0, s32, 24576
    s_add_u32 s37, s57, 180224
    buffer_load_dwordx4 v253, s[20:23], s37 offen offset:2048 nt lds
    ds_read_b128 a[128:131], v235 offset:24576
    ds_read_b128 a[132:135], v235 offset:32768
    v_add_f32 v247, v247, v173
    v_exp_f32 v175, v175
    v_add_f32 v246, v246, v174
    v_cvt_pk_bf16_f32 v168, v168, v169
    v_mfma_f32_32x32x16_bf16 v[16:31], a[104:107], a[144:147], v[16:31]
    ds_read_b128 a[136:139], v235 offset:40960
    v_add_f32 v247, v247, v175
    v_cvt_pk_bf16_f32 v169, v170, v171
    v_cvt_pk_bf16_f32 v170, v172, v173
    v_cvt_pk_bf16_f32 v171, v174, v175
    v_mfma_f32_32x32x16_bf16 v[32:47], a[104:107], a[148:151], v[32:47]
    s_waitcnt vmcnt(15)
    ds_read_b64_tr_b16 a[96:97], v224 offset:10240
    ds_write_b128 v226, v[128:131] offset:16384
    v_fma_f32 v176, v176, s33, -v243
    v_fma_f32 v177, v177, s33, -v243
    s_waitcnt lgkmcnt(13)
    v_mfma_f32_32x32x16_bf16 a[48:63], a[108:111], a[140:143], a[48:63]
    buffer_load_dwordx4 v254, s[20:23], s37 offen offset:3072 nt lds
    ds_read_b64_tr_b16 a[98:99], v224 offset:11264
    v_exp_f32 v176, v176
    v_fma_f32 v178, v178, s33, -v243
    v_exp_f32 v177, v177
    v_add_f32 v248, v248, v176
    v_mfma_f32_32x32x16_bf16 a[64:79], a[108:111], a[144:147], a[64:79]
    ds_read_b64_tr_b16 a[100:101], v225 offset:10240
    v_fma_f32 v179, v179, s33, -v243
    v_exp_f32 v178, v178
    v_add_f32 v249, v249, v177
    v_fma_f32 v180, v180, s33, -v243
    v_mfma_f32_32x32x16_bf16 a[80:95], a[108:111], a[148:151], a[80:95]
    ds_read_b64_tr_b16 a[102:103], v225 offset:11264
    v_exp_f32 v179, v179
    v_add_f32 v248, v248, v178
    v_fma_f32 v181, v181, s33, -v243
    s_waitcnt lgkmcnt(10)
    v_mfma_f32_32x32x16_bf16 v[0:15], a[112:115], a[152:155], v[0:15]
    s_add_u32 m0, s32, 0
    s_add_u32 s37, s53, 196608
    buffer_load_dwordx4 v222, s[20:23], s37 offen offset:0 nt lds
    s_waitcnt vmcnt(15)
    ds_read_b64_tr_b16 a[104:105], v224 offset:12288
    v_exp_f32 v180, v180
    v_add_f32 v249, v249, v179
    v_fma_f32 v182, v182, s33, -v243
    v_exp_f32 v181, v181
    v_mfma_f32_32x32x16_bf16 v[16:31], a[112:115], a[156:159], v[16:31]
    ds_read_b64_tr_b16 a[106:107], v224 offset:13312
    v_add_f32 v248, v248, v180
    v_fma_f32 v183, v183, s33, -v243
    v_exp_f32 v182, v182
    v_add_f32 v249, v249, v181
    v_mfma_f32_32x32x16_bf16 v[32:47], a[112:115], a[160:163], v[32:47]
    v_exp_f32 v183, v183
    v_add_f32 v248, v248, v182
    v_cvt_pk_bf16_f32 v176, v176, v177
    s_waitcnt lgkmcnt(10)
    v_mfma_f32_32x32x16_bf16 a[48:63], a[116:119], a[152:155], a[48:63]
    buffer_load_dwordx4 v223, s[20:23], s37 offen offset:1024 nt lds
    ds_read_b64_tr_b16 a[108:109], v225 offset:12288
    v_add_f32 v249, v249, v183
    v_cvt_pk_bf16_f32 v177, v178, v179
    v_cvt_pk_bf16_f32 v178, v180, v181
    v_cvt_pk_bf16_f32 v179, v182, v183
    v_mfma_f32_32x32x16_bf16 a[64:79], a[116:119], a[156:159], a[64:79]
    ds_read_b64_tr_b16 a[110:111], v225 offset:13312
    ds_write_b128 v227, v[136:139] offset:16384
    v_fma_f32 v184, v184, s33, -v243
    v_fma_f32 v185, v185, s33, -v243
    v_exp_f32 v184, v184
    v_mfma_f32_32x32x16_bf16 a[80:95], a[116:119], a[160:163], a[80:95]
    v_fma_f32 v186, v186, s33, -v243
    v_exp_f32 v185, v185
    v_add_f32 v248, v248, v184
    s_waitcnt lgkmcnt(7)
    v_mfma_f32_32x32x16_bf16 v[0:15], a[96:99], a[128:131], v[0:15]
    s_add_u32 m0, s32, 0
    s_add_u32 s37, s53, 196608
    buffer_load_dwordx4 v253, s[20:23], s37 offen offset:2048 nt lds
    s_waitcnt vmcnt(15)
    ds_read_b64_tr_b16 a[112:113], v224 offset:14336
    v_fma_f32 v187, v187, s33, -v243
    v_exp_f32 v186, v186
    v_add_f32 v249, v249, v185
    v_fma_f32 v188, v188, s33, -v243
    v_mfma_f32_32x32x16_bf16 v[16:31], a[96:99], a[132:135], v[16:31]
    ds_read_b64_tr_b16 a[114:115], v224 offset:15360
    v_exp_f32 v187, v187
    v_add_f32 v248, v248, v186
    v_fma_f32 v189, v189, s33, -v243
    v_exp_f32 v188, v188
    v_mfma_f32_32x32x16_bf16 v[32:47], a[96:99], a[136:139], v[32:47]
    v_add_f32 v249, v249, v187
    v_fma_f32 v190, v190, s33, -v243
    v_exp_f32 v189, v189
    s_waitcnt lgkmcnt(7)
    v_mfma_f32_32x32x16_bf16 a[48:63], a[100:103], a[128:131], a[48:63]
    buffer_load_dwordx4 v254, s[20:23], s37 offen offset:3072 nt lds
    ds_read_b64_tr_b16 a[116:117], v225 offset:14336
    v_add_f32 v248, v248, v188
    v_fma_f32 v191, v191, s33, -v243
    v_exp_f32 v190, v190
    v_add_f32 v249, v249, v189
    v_mfma_f32_32x32x16_bf16 a[64:79], a[100:103], a[132:135], a[64:79]
    ds_read_b64_tr_b16 a[118:119], v225 offset:15360
    v_exp_f32 v191, v191
    v_add_f32 v248, v248, v190
    v_cvt_pk_bf16_f32 v184, v184, v185
    v_add_f32 v249, v249, v191
    v_mfma_f32_32x32x16_bf16 a[80:95], a[100:103], a[136:139], a[80:95]
    v_cvt_pk_bf16_f32 v185, v186, v187
    v_cvt_pk_bf16_f32 v186, v188, v189
    v_cvt_pk_bf16_f32 v187, v190, v191
    s_waitcnt lgkmcnt(4)
    s_barrier
    ds_read_b128 a[140:143], v228 offset:0
    ds_read_b128 a[144:147], v228 offset:8192
    ds_read_b128 a[148:151], v228 offset:16384
    ds_read_b128 a[152:155], v229 offset:0
    ds_read_b128 a[156:159], v229 offset:8192
    ds_read_b128 a[160:163], v229 offset:16384
    s_waitcnt lgkmcnt(5)
    v_mfma_f32_32x32x16_bf16 v[0:15], a[104:107], a[140:143], v[0:15]
    s_add_u32 m0, s32, 4096
    s_add_u32 s37, s53, 212992
    buffer_load_dwordx4 v222, s[20:23], s37 offen offset:0 nt lds
    ds_read_b128 a[128:131], v230 offset:0
    ds_read_b128 a[132:135], v230 offset:8192
    s_waitcnt lgkmcnt(6)
    v_mfma_f32_32x32x16_bf16 v[16:31], a[104:107], a[144:147], v[16:31]
    ds_read_b128 a[136:139], v230 offset:16384
    s_waitcnt lgkmcnt(6)
    v_mfma_f32_32x32x16_bf16 v[32:47], a[104:107], a[148:151], v[32:47]
    s_waitcnt vmcnt(15)
    ds_read_b64_tr_b16 a[96:97], v224 offset:16384
    v_mfma_f32_32x32x16_bf16 a[48:63], a[108:111], a[140:143], a[48:63]
    buffer_load_dwordx4 v223, s[20:23], s37 offen offset:1024 nt lds
    ds_read_b64_tr_b16 a[98:99], v224 offset:17408
    v_mfma_f32_32x32x16_bf16 a[64:79], a[108:111], a[144:147], a[64:79]
    ds_read_b64_tr_b16 a[100:101], v225 offset:16384
    v_mfma_f32_32x32x16_bf16 a[80:95], a[108:111], a[148:151], a[80:95]
    ds_read_b64_tr_b16 a[102:103], v225 offset:17408
    s_waitcnt lgkmcnt(9)
    v_mfma_f32_32x32x16_bf16 v[0:15], a[112:115], a[152:155], v[0:15]
    s_add_u32 m0, s32, 4096
    s_add_u32 s37, s53, 212992
    buffer_load_dwordx4 v253, s[20:23], s37 offen offset:2048 nt lds
    ds_read_b128 a[140:143], v231 offset:0
    ds_read_b128 a[144:147], v231 offset:8192
    ds_write_b128 v226, v[144:147] offset:24576
    s_waitcnt lgkmcnt(11)
    v_mfma_f32_32x32x16_bf16 v[16:31], a[112:115], a[156:159], v[16:31]
    ds_read_b128 a[148:151], v231 offset:16384
    s_waitcnt lgkmcnt(11)
    v_mfma_f32_32x32x16_bf16 v[32:47], a[112:115], a[160:163], v[32:47]
    s_waitcnt vmcnt(15)
    ds_read_b64_tr_b16 a[104:105], v224 offset:18432
    v_mfma_f32_32x32x16_bf16 a[48:63], a[116:119], a[152:155], a[48:63]
    buffer_load_dwordx4 v254, s[20:23], s37 offen offset:3072 nt lds
    ds_read_b64_tr_b16 a[106:107], v224 offset:19456
    v_mfma_f32_32x32x16_bf16 a[64:79], a[116:119], a[156:159], a[64:79]
    ds_read_b64_tr_b16 a[108:109], v225 offset:18432
    v_mfma_f32_32x32x16_bf16 a[80:95], a[116:119], a[160:163], a[80:95]
    ds_read_b64_tr_b16 a[110:111], v225 offset:19456
    s_waitcnt lgkmcnt(10)
    v_mfma_f32_32x32x16_bf16 v[0:15], a[96:99], a[128:131], v[0:15]
    s_add_u32 m0, s32, 8192
    s_add_u32 s37, s53, 229376
    buffer_load_dwordx4 v222, s[20:23], s37 offen offset:0 nt lds
    ds_read_b128 a[152:155], v232 offset:0
    ds_read_b128 a[156:159], v232 offset:8192
    ds_write_b128 v227, v[152:155] offset:24576
    v_mfma_f32_32x32x16_bf16 v[16:31], a[96:99], a[132:135], v[16:31]
    ds_read_b128 a[160:163], v232 offset:16384
    v_mfma_f32_32x32x16_bf16 v[32:47], a[96:99], a[136:139], v[32:47]
    s_waitcnt vmcnt(15)
    ds_read_b64_tr_b16 a[112:113], v224 offset:20480
    s_waitcnt lgkmcnt(13)
    v_mfma_f32_32x32x16_bf16 a[48:63], a[100:103], a[128:131], a[48:63]
    buffer_load_dwordx4 v223, s[20:23], s37 offen offset:1024 nt lds
    ds_read_b64_tr_b16 a[114:115], v224 offset:21504
    v_mfma_f32_32x32x16_bf16 a[64:79], a[100:103], a[132:135], a[64:79]
    ds_read_b64_tr_b16 a[116:117], v225 offset:20480
    v_mfma_f32_32x32x16_bf16 a[80:95], a[100:103], a[136:139], a[80:95]
    ds_read_b64_tr_b16 a[118:119], v225 offset:21504
    s_waitcnt lgkmcnt(10)
    v_mfma_f32_32x32x16_bf16 v[0:15], a[104:107], a[140:143], v[0:15]
    s_add_u32 m0, s32, 8192
    s_add_u32 s37, s53, 229376
    buffer_load_dwordx4 v253, s[20:23], s37 offen offset:2048 nt lds
    ds_read_b128 a[128:131], v233 offset:0
    ds_read_b128 a[132:135], v233 offset:8192
    ds_write_b128 v226, v[160:163] offset:32768
    v_mfma_f32_32x32x16_bf16 v[16:31], a[104:107], a[144:147], v[16:31]
    ds_read_b128 a[136:139], v233 offset:16384
    v_mfma_f32_32x32x16_bf16 v[32:47], a[104:107], a[148:151], v[32:47]
    s_waitcnt vmcnt(15)
    ds_read_b64_tr_b16 a[96:97], v224 offset:22528
    s_waitcnt lgkmcnt(13)
    v_mfma_f32_32x32x16_bf16 a[48:63], a[108:111], a[140:143], a[48:63]
    buffer_load_dwordx4 v254, s[20:23], s37 offen offset:3072 nt lds
    ds_read_b64_tr_b16 a[98:99], v224 offset:23552
    v_mfma_f32_32x32x16_bf16 a[64:79], a[108:111], a[144:147], a[64:79]
    ds_read_b64_tr_b16 a[100:101], v225 offset:22528
    v_mfma_f32_32x32x16_bf16 a[80:95], a[108:111], a[148:151], a[80:95]
    ds_read_b64_tr_b16 a[102:103], v225 offset:23552
    s_waitcnt lgkmcnt(10)
    v_mfma_f32_32x32x16_bf16 v[0:15], a[112:115], a[152:155], v[0:15]
    s_add_u32 m0, s32, 12288
    s_add_u32 s37, s53, 245760
    buffer_load_dwordx4 v222, s[20:23], s37 offen offset:0 nt lds
    ds_read_b128 a[140:143], v234 offset:0
    ds_read_b128 a[144:147], v234 offset:8192
    v_mfma_f32_32x32x16_bf16 v[16:31], a[112:115], a[156:159], v[16:31]
    ds_read_b128 a[148:151], v234 offset:16384
    v_mfma_f32_32x32x16_bf16 v[32:47], a[112:115], a[160:163], v[32:47]
    s_waitcnt vmcnt(15)
    ds_read_b64_tr_b16 a[104:105], v224 offset:24576
    s_waitcnt lgkmcnt(12)
    v_mfma_f32_32x32x16_bf16 a[48:63], a[116:119], a[152:155], a[48:63]
    buffer_load_dwordx4 v223, s[20:23], s37 offen offset:1024 nt lds
    ds_read_b64_tr_b16 a[106:107], v224 offset:25600
    v_mfma_f32_32x32x16_bf16 a[64:79], a[116:119], a[156:159], a[64:79]
    ds_read_b64_tr_b16 a[108:109], v225 offset:24576
    v_mfma_f32_32x32x16_bf16 a[80:95], a[116:119], a[160:163], a[80:95]
    ds_read_b64_tr_b16 a[110:111], v225 offset:25600
    s_waitcnt lgkmcnt(9)
    v_mfma_f32_32x32x16_bf16 v[0:15], a[96:99], a[128:131], v[0:15]
    s_add_u32 m0, s32, 12288
    s_add_u32 s37, s53, 245760
    buffer_load_dwordx4 v253, s[20:23], s37 offen offset:2048 nt lds
    ds_read_b128 a[152:155], v235 offset:0
    ds_read_b128 a[156:159], v235 offset:8192
    ds_write_b128 v227, v[168:171] offset:32768
    v_mfma_f32_32x32x16_bf16 v[16:31], a[96:99], a[132:135], v[16:31]
    ds_read_b128 a[160:163], v235 offset:16384
    v_mfma_f32_32x32x16_bf16 v[32:47], a[96:99], a[136:139], v[32:47]
    s_waitcnt vmcnt(15)
    ds_read_b64_tr_b16 a[112:113], v224 offset:26624
    s_waitcnt lgkmcnt(12)
    v_mfma_f32_32x32x16_bf16 a[48:63], a[100:103], a[128:131], a[48:63]
    buffer_load_dwordx4 v254, s[20:23], s37 offen offset:3072 nt lds
    ds_read_b64_tr_b16 a[114:115], v224 offset:27648
    v_mfma_f32_32x32x16_bf16 a[64:79], a[100:103], a[132:135], a[64:79]
    ds_read_b64_tr_b16 a[116:117], v225 offset:26624
    v_mfma_f32_32x32x16_bf16 a[80:95], a[100:103], a[136:139], a[80:95]
    ds_read_b64_tr_b16 a[118:119], v225 offset:27648
    s_waitcnt lgkmcnt(10)
    v_mfma_f32_32x32x16_bf16 v[0:15], a[104:107], a[140:143], v[0:15]
    s_waitcnt vmcnt(14)
    ds_read_b64_tr_b16 a[96:97], v224 offset:0
    ds_write_b128 v226, v[176:179] offset:40960
    v_mfma_f32_32x32x16_bf16 v[16:31], a[104:107], a[144:147], v[16:31]
    ds_read_b64_tr_b16 a[98:99], v224 offset:1024
    v_mfma_f32_32x32x16_bf16 v[32:47], a[104:107], a[148:151], v[32:47]
    s_waitcnt lgkmcnt(11)
    v_mfma_f32_32x32x16_bf16 a[48:63], a[108:111], a[140:143], a[48:63]
    ds_read_b64_tr_b16 a[100:101], v225 offset:0
    v_mfma_f32_32x32x16_bf16 a[64:79], a[108:111], a[144:147], a[64:79]
    ds_read_b64_tr_b16 a[102:103], v225 offset:1024
    v_mfma_f32_32x32x16_bf16 a[80:95], a[108:111], a[148:151], a[80:95]
    s_waitcnt lgkmcnt(7)
    v_mfma_f32_32x32x16_bf16 v[0:15], a[112:115], a[152:155], v[0:15]
    s_waitcnt vmcnt(12)
    ds_read_b64_tr_b16 a[104:105], v224 offset:2048
    ds_write_b128 v227, v[184:187] offset:40960
    v_mfma_f32_32x32x16_bf16 v[16:31], a[112:115], a[156:159], v[16:31]
    ds_read_b64_tr_b16 a[106:107], v224 offset:3072
    v_mfma_f32_32x32x16_bf16 v[32:47], a[112:115], a[160:163], v[32:47]
    s_waitcnt lgkmcnt(8)
    v_mfma_f32_32x32x16_bf16 a[48:63], a[116:119], a[152:155], a[48:63]
    ds_read_b64_tr_b16 a[108:109], v225 offset:2048
    v_mfma_f32_32x32x16_bf16 a[64:79], a[116:119], a[156:159], a[64:79]
    ds_read_b64_tr_b16 a[110:111], v225 offset:3072
    v_mfma_f32_32x32x16_bf16 a[80:95], a[116:119], a[160:163], a[80:95]
    s_waitcnt lgkmcnt(3)
    s_barrier
    ds_read_b128 a[128:131], v228 offset:24576
    ds_read_b128 a[132:135], v228 offset:32768
    ds_read_b128 a[136:139], v228 offset:40960
    ds_read_b128 a[140:143], v229 offset:24576
    ds_read_b128 a[144:147], v229 offset:32768
    ds_read_b128 a[148:151], v229 offset:40960
    s_waitcnt lgkmcnt(5)
    v_mfma_f32_32x32x16_bf16 v[0:15], a[96:99], a[128:131], v[0:15]
    ds_read_b128 a[152:155], v230 offset:24576
    ds_read_b128 a[156:159], v230 offset:32768
    v_add_f32 v244, v244, v245
    v_add_f32 v246, v246, v247
    s_waitcnt lgkmcnt(6)
    v_mfma_f32_32x32x16_bf16 v[16:31], a[96:99], a[132:135], v[16:31]
    ds_read_b128 a[160:163], v230 offset:40960
    v_add_f32 v248, v248, v249
    s_waitcnt lgkmcnt(6)
    v_mfma_f32_32x32x16_bf16 v[32:47], a[96:99], a[136:139], v[32:47]
    s_waitcnt vmcnt(10)
    ds_read_b64_tr_b16 a[112:113], v224 offset:4096
    v_mov_b32 v250, v244
    v_mfma_f32_32x32x16_bf16 a[48:63], a[100:103], a[128:131], a[48:63]
    ds_read_b64_tr_b16 a[114:115], v224 offset:5120
    v_mov_b32 v251, v246
    v_mov_b32 v252, v248
    v_mfma_f32_32x32x16_bf16 a[64:79], a[100:103], a[132:135], a[64:79]
    ds_read_b64_tr_b16 a[116:117], v225 offset:4096
    s_nop 0
    v_mfma_f32_32x32x16_bf16 a[80:95], a[100:103], a[136:139], a[80:95]
    ds_read_b64_tr_b16 a[118:119], v225 offset:5120
    v_permlane32_swap_b32 v244, v250
    s_waitcnt lgkmcnt(9)
    v_mfma_f32_32x32x16_bf16 v[0:15], a[104:107], a[140:143], v[0:15]
    s_add_u32 m0, s32, 21504
    s_add_u32 s37, s101, 0
    buffer_load_dwordx4 v200, s[24:27], s37 offen offset:0  lds
    ds_read_b128 a[128:131], v231 offset:24576
    ds_read_b128 a[132:135], v231 offset:32768
    v_permlane32_swap_b32 v246, v251
    v_permlane32_swap_b32 v248, v252
    s_waitcnt lgkmcnt(10)
    v_mfma_f32_32x32x16_bf16 v[16:31], a[104:107], a[144:147], v[16:31]
    ds_read_b128 a[136:139], v231 offset:40960
    v_add_f32 v244, v244, v250
    s_waitcnt lgkmcnt(10)
    v_mfma_f32_32x32x16_bf16 v[32:47], a[104:107], a[148:151], v[32:47]
    s_waitcnt vmcnt(9)
    ds_read_b64_tr_b16 a[96:97], v224 offset:6144
    v_add_f32 v246, v246, v251
    v_mfma_f32_32x32x16_bf16 a[48:63], a[108:111], a[140:143], a[48:63]
    buffer_load_dwordx4 v201, s[24:27], s37 offen offset:1024  lds
    ds_read_b64_tr_b16 a[98:99], v224 offset:7168
    v_add_f32 v248, v248, v252
    ds_write_b32 v236, v244 offset:0
    v_mfma_f32_32x32x16_bf16 a[64:79], a[108:111], a[144:147], a[64:79]
    ds_read_b64_tr_b16 a[100:101], v225 offset:6144
    ds_write_b32 v236, v246 offset:512
    v_mfma_f32_32x32x16_bf16 a[80:95], a[108:111], a[148:151], a[80:95]
    ds_read_b64_tr_b16 a[102:103], v225 offset:7168
    ds_write_b32 v236, v248 offset:1024
    s_waitcnt lgkmcnt(12)
    v_mfma_f32_32x32x16_bf16 v[0:15], a[112:115], a[152:155], v[0:15]
    s_add_u32 m0, s32, 21504
    s_add_u32 s37, s101, 0
    buffer_load_dwordx4 v202, s[24:27], s37 offen offset:2048  lds
    ds_read_b128 a[140:143], v232 offset:24576
    ds_read_b128 a[144:147], v232 offset:32768
    v_mfma_f32_32x32x16_bf16 v[16:31], a[112:115], a[156:159], v[16:31]
    ds_read_b128 a[148:151], v232 offset:40960
    v_mfma_f32_32x32x16_bf16 v[32:47], a[112:115], a[160:163], v[32:47]
    s_waitcnt vmcnt(9)
    ds_read_b64_tr_b16 a[104:105], v224 offset:8192
    s_waitcnt lgkmcnt(14)
    v_mfma_f32_32x32x16_bf16 a[48:63], a[116:119], a[152:155], a[48:63]
    buffer_load_dwordx4 v203, s[24:27], s37 offen offset:3072  lds
    ds_read_b64_tr_b16 a[106:107], v224 offset:9216
    v_mfma_f32_32x32x16_bf16 a[64:79], a[116:119], a[156:159], a[64:79]
    ds_read_b64_tr_b16 a[108:109], v225 offset:8192
    v_mfma_f32_32x32x16_bf16 a[80:95], a[116:119], a[160:163], a[80:95]
    ds_read_b64_tr_b16 a[110:111], v225 offset:9216
    s_waitcnt lgkmcnt(12)
    v_mfma_f32_32x32x16_bf16 v[0:15], a[96:99], a[128:131], v[0:15]
    s_add_u32 m0, s32, 25600
    s_add_u32 s37, s101, 0
    buffer_load_dwordx4 v204, s[24:27], s37 offen offset:0  lds
    ds_read_b128 a[152:155], v233 offset:24576
    ds_read_b128 a[156:159], v233 offset:32768
    s_waitcnt lgkmcnt(9)
    v_mfma_f32_32x32x16_bf16 v[16:31], a[96:99], a[132:135], v[16:31]
    ds_read_b128 a[160:163], v233 offset:40960
    v_mfma_f32_32x32x16_bf16 v[32:47], a[96:99], a[136:139], v[32:47]
    s_waitcnt vmcnt(9)
    ds_read_b64_tr_b16 a[112:113], v224 offset:10240
    v_mfma_f32_32x32x16_bf16 a[48:63], a[100:103], a[128:131], a[48:63]
    buffer_load_dwordx4 v205, s[24:27], s37 offen offset:1024  lds
    ds_read_b64_tr_b16 a[114:115], v224 offset:11264
    s_barrier
    v_mfma_f32_32x32x16_bf16 a[64:79], a[100:103], a[132:135], a[64:79]
    ds_read_b64_tr_b16 a[116:117], v225 offset:10240
    v_mfma_f32_32x32x16_bf16 a[80:95], a[100:103], a[136:139], a[80:95]
    ds_read_b64_tr_b16 a[118:119], v225 offset:11264
    s_waitcnt lgkmcnt(9)
    v_mfma_f32_32x32x16_bf16 v[0:15], a[104:107], a[140:143], v[0:15]
    s_add_u32 m0, s32, 25600
    s_add_u32 s37, s101, 0
    buffer_load_dwordx4 v206, s[24:27], s37 offen offset:2048  lds
    ds_read_b128 a[128:131], v234 offset:24576
    ds_read_b128 a[132:135], v234 offset:32768
    ds_read_b128 v[192:195], v237 offset:0
    v_mfma_f32_32x32x16_bf16 v[16:31], a[104:107], a[144:147], v[16:31]
    ds_read_b128 a[136:139], v234 offset:40960
    v_mfma_f32_32x32x16_bf16 v[32:47], a[104:107], a[148:151], v[32:47]
    s_waitcnt vmcnt(9)
    ds_read_b64_tr_b16 a[96:97], v224 offset:12288
    ds_read_b128 v[196:199], v237 offset:512
    s_waitcnt lgkmcnt(13)
    v_mfma_f32_32x32x16_bf16 a[48:63], a[108:111], a[140:143], a[48:63]
    s_add_u32 m0, s32, 0
    s_add_u32 s37, s101, 28672
    buffer_load_dwordx4 v200, s[24:27], s37 offen offset:0  lds
    ds_read_b64_tr_b16 a[98:99], v224 offset:13312
    v_mfma_f32_32x32x16_bf16 a[64:79], a[108:111], a[144:147], a[64:79]
    ds_read_b64_tr_b16 a[100:101], v225 offset:12288
    ds_read_b128 v[218:221], v237 offset:1024
    v_mfma_f32_32x32x16_bf16 a[80:95], a[108:111], a[148:151], a[80:95]
    ds_read_b64_tr_b16 a[102:103], v225 offset:13312
    s_waitcnt lgkmcnt(12)
    v_mfma_f32_32x32x16_bf16 v[0:15], a[112:115], a[152:155], v[0:15]
    s_add_u32 m0, s32, 0
    s_add_u32 s37, s101, 28672
    buffer_load_dwordx4 v201, s[24:27], s37 offen offset:1024  lds
    ds_read_b128 a[140:143], v235 offset:24576
    ds_read_b128 a[144:147], v235 offset:32768
    v_mfma_f32_32x32x16_bf16 v[16:31], a[112:115], a[156:159], v[16:31]
    ds_read_b128 a[148:151], v235 offset:40960
    v_mfma_f32_32x32x16_bf16 v[32:47], a[112:115], a[160:163], v[32:47]
    s_waitcnt vmcnt(9)
    ds_read_b64_tr_b16 a[104:105], v224 offset:14336
    s_waitcnt lgkmcnt(14)
    v_mfma_f32_32x32x16_bf16 a[48:63], a[116:119], a[152:155], a[48:63]
    buffer_load_dwordx4 v202, s[24:27], s37 offen offset:2048  lds
    ds_read_b64_tr_b16 a[106:107], v224 offset:15360
    v_mfma_f32_32x32x16_bf16 a[64:79], a[116:119], a[156:159], a[64:79]
    ds_read_b64_tr_b16 a[108:109], v225 offset:14336
    v_mfma_f32_32x32x16_bf16 a[80:95], a[116:119], a[160:163], a[80:95]
    ds_read_b64_tr_b16 a[110:111], v225 offset:15360
    s_waitcnt lgkmcnt(10)
    v_mfma_f32_32x32x16_bf16 v[0:15], a[96:99], a[128:131], v[0:15]
    s_add_u32 m0, s32, 0
    s_add_u32 s37, s101, 28672
    buffer_load_dwordx4 v203, s[24:27], s37 offen offset:3072  lds
    v_add_f32 v192, v192, v193
    v_add_f32 v194, v194, v195
    v_mfma_f32_32x32x16_bf16 v[16:31], a[96:99], a[132:135], v[16:31]
    v_add_f32 v192, v192, v194
    v_rcp_f32 v241, v192
    v_mfma_f32_32x32x16_bf16 v[32:47], a[96:99], a[136:139], v[32:47]
    v_add_f32 v196, v196, v197
    v_add_f32 v198, v198, v199
    s_waitcnt lgkmcnt(7)
    v_mfma_f32_32x32x16_bf16 a[48:63], a[100:103], a[128:131], a[48:63]
    s_add_u32 m0, s32, 4096
    s_add_u32 s37, s101, 28672
    buffer_load_dwordx4 v204, s[24:27], s37 offen offset:0  lds
    v_add_f32 v196, v196, v198
    v_rcp_f32 v242, v196
    v_mfma_f32_32x32x16_bf16 a[64:79], a[100:103], a[132:135], a[64:79]
    v_add_f32 v218, v218, v219
    v_add_f32 v220, v220, v221
    v_mfma_f32_32x32x16_bf16 a[80:95], a[100:103], a[136:139], a[80:95]
    v_add_f32 v218, v218, v220
    v_rcp_f32 v243, v218
    s_waitcnt lgkmcnt(2)
    v_mfma_f32_32x32x16_bf16 v[0:15], a[104:107], a[140:143], v[0:15]
    s_add_u32 m0, s32, 4096
    s_add_u32 s37, s101, 28672
    buffer_load_dwordx4 v205, s[24:27], s37 offen offset:1024  lds
    s_waitcnt lgkmcnt(0)
    v_mfma_f32_32x32x16_bf16 v[16:31], a[104:107], a[144:147], v[16:31]
    v_mfma_f32_32x32x16_bf16 v[32:47], a[104:107], a[148:151], v[32:47]
    v_mfma_f32_32x32x16_bf16 a[48:63], a[108:111], a[140:143], a[48:63]
    buffer_load_dwordx4 v206, s[24:27], s37 offen offset:2048  lds
    s_barrier
    v_mfma_f32_32x32x16_bf16 a[64:79], a[108:111], a[144:147], a[64:79]
    v_mfma_f32_32x32x16_bf16 a[80:95], a[108:111], a[148:151], a[80:95]
    s_lshl_b32 s38, s3, 7
    v_xor_b32 v214, s38, v212
    s_lshl_b32 s38, s59, 8
    v_xor_b32 v209, s38, v208
    v_xor_b32 v210, 64, v209
    v_xor_b32 v211, 128, v209
    v_xor_b32 v212, 192, v209
    s_xor_b32 s59, s59, 1
    s_mul_i32 s58, s59, 114688
    s_mul_i32 s38, s3, 224
    s_add_u32 s58, s58, s38
    s_waitcnt vmcnt(7)
    ds_read_b64_tr_b16 a[0:1], v207 offset:21504
    ds_read_b64_tr_b16 a[2:3], v207 offset:23296
    ds_read_b64_tr_b16 a[4:5], v207 offset:21536
    ds_read_b64_tr_b16 a[6:7], v207 offset:23328
    ds_read_b64_tr_b16 a[8:9], v207 offset:21568
    ds_read_b64_tr_b16 a[10:11], v207 offset:23360
    ds_read_b64_tr_b16 a[128:129], v207 offset:21600
    ds_read_b64_tr_b16 a[130:131], v207 offset:23392
    ds_read_b64_tr_b16 a[132:133], v207 offset:21632
    ds_read_b64_tr_b16 a[134:135], v207 offset:23424
    ds_read_b64_tr_b16 a[136:137], v207 offset:21664
    ds_read_b64_tr_b16 a[138:139], v207 offset:23456
    ds_read_b64_tr_b16 a[140:141], v207 offset:21696
    ds_read_b64_tr_b16 a[142:143], v207 offset:23488
    s_add_u32 m0, s32, 7168
    s_add_u32 s37, s101, 57344
    buffer_load_dwordx4 v200, s[24:27], s37 offen offset:0  lds
    v_mul_f32 v0, v0, v241
    v_mul_f32 v1, v1, v241
    v_mul_f32 v2, v2, v241
    v_mul_f32 v3, v3, v241
    v_mul_f32 v4, v4, v241
    v_mul_f32 v5, v5, v241
    v_mul_f32 v6, v6, v241
    v_mul_f32 v7, v7, v241
    v_cvt_pk_bf16_f32 v56, v0, v1
    v_cvt_pk_bf16_f32 v57, v2, v3
    v_cvt_pk_bf16_f32 v58, v4, v5
    v_cvt_pk_bf16_f32 v59, v6, v7
    ds_write_b128 v214, v[56:59] offset:0
    v_mul_f32 v16, v16, v242
    buffer_load_dwordx4 v201, s[24:27], s37 offen offset:1024  lds
    v_mul_f32 v17, v17, v242
    v_mul_f32 v18, v18, v242
    v_mul_f32 v19, v19, v242
    v_mul_f32 v20, v20, v242
    v_mul_f32 v21, v21, v242
    v_mul_f32 v22, v22, v242
    v_mul_f32 v23, v23, v242
    v_cvt_pk_bf16_f32 v72, v16, v17
    v_cvt_pk_bf16_f32 v73, v18, v19
    v_cvt_pk_bf16_f32 v74, v20, v21
    v_cvt_pk_bf16_f32 v75, v22, v23
    ds_write_b128 v214, v[72:75] offset:16384
    v_mul_f32 v32, v32, v243
    v_mul_f32 v33, v33, v243
    v_mul_f32 v34, v34, v243
    buffer_load_dwordx4 v202, s[24:27], s37 offen offset:2048  lds
    v_mul_f32 v35, v35, v243
    v_mul_f32 v36, v36, v243
    v_mul_f32 v37, v37, v243
    v_mul_f32 v38, v38, v243
    v_mul_f32 v39, v39, v243
    v_cvt_pk_bf16_f32 v88, v32, v33
    v_cvt_pk_bf16_f32 v89, v34, v35
    v_cvt_pk_bf16_f32 v90, v36, v37
    v_cvt_pk_bf16_f32 v91, v38, v39
    ds_write_b128 v214, v[88:91] offset:32768
    v_xor_b32 v215, 32, v214
    v_mul_f32 v8, v8, v241
    v_mul_f32 v9, v9, v241
    v_mul_f32 v10, v10, v241
    v_mul_f32 v11, v11, v241
    buffer_load_dwordx4 v203, s[24:27], s37 offen offset:3072  lds
    v_mul_f32 v12, v12, v241
    v_mul_f32 v13, v13, v241
    v_mul_f32 v14, v14, v241
    v_mul_f32 v15, v15, v241
    v_cvt_pk_bf16_f32 v56, v8, v9
    v_cvt_pk_bf16_f32 v57, v10, v11
    v_cvt_pk_bf16_f32 v58, v12, v13
    v_cvt_pk_bf16_f32 v59, v14, v15
    ds_write_b128 v215, v[56:59] offset:0
    v_mul_f32 v24, v24, v242
    v_mul_f32 v25, v25, v242
    v_mul_f32 v26, v26, v242
    v_mul_f32 v27, v27, v242
    v_mul_f32 v28, v28, v242
    v_mul_f32 v29, v29, v242
    s_add_u32 m0, s32, 11264
    s_add_u32 s37, s101, 57344
    buffer_load_dwordx4 v204, s[24:27], s37 offen offset:0  lds
    v_mul_f32 v30, v30, v242
    v_mul_f32 v31, v31, v242
    v_cvt_pk_bf16_f32 v72, v24, v25
    v_cvt_pk_bf16_f32 v73, v26, v27
    v_cvt_pk_bf16_f32 v74, v28, v29
    v_cvt_pk_bf16_f32 v75, v30, v31
    ds_write_b128 v215, v[72:75] offset:16384
    v_mul_f32 v40, v40, v243
    v_mul_f32 v41, v41, v243
    v_mul_f32 v42, v42, v243
    v_mul_f32 v43, v43, v243
    v_mul_f32 v44, v44, v243
    v_mul_f32 v45, v45, v243
    v_mul_f32 v46, v46, v243
    buffer_load_dwordx4 v205, s[24:27], s37 offen offset:1024  lds
    v_mul_f32 v47, v47, v243
    v_cvt_pk_bf16_f32 v88, v40, v41
    v_cvt_pk_bf16_f32 v89, v42, v43
    v_cvt_pk_bf16_f32 v90, v44, v45
    v_cvt_pk_bf16_f32 v91, v46, v47
    ds_write_b128 v215, v[88:91] offset:32768
    v_xor_b32 v215, 64, v214
    v_accvgpr_read_b32 v48, a48
    v_accvgpr_read_b32 v49, a49
    v_accvgpr_read_b32 v50, a50
    v_accvgpr_read_b32 v51, a51
    v_accvgpr_read_b32 v52, a52
    v_accvgpr_read_b32 v53, a53
    v_accvgpr_read_b32 v54, a54
    v_accvgpr_read_b32 v55, a55
    buffer_load_dwordx4 v206, s[24:27], s37 offen offset:2048  lds
    v_mul_f32 v48, v48, v241
    v_mul_f32 v49, v49, v241
    v_mul_f32 v50, v50, v241
    v_mul_f32 v51, v51, v241
    v_mul_f32 v52, v52, v241
    v_mul_f32 v53, v53, v241
    v_mul_f32 v54, v54, v241
    v_mul_f32 v55, v55, v241
    v_cvt_pk_bf16_f32 v56, v48, v49
    v_cvt_pk_bf16_f32 v57, v50, v51
    v_cvt_pk_bf16_f32 v58, v52, v53
    v_cvt_pk_bf16_f32 v59, v54, v55
    ds_write_b128 v215, v[56:59] offset:0
    v_accvgpr_read_b32 v64, a64
    v_accvgpr_read_b32 v65, a65
    s_add_u32 m0, s32, 14336
    s_add_u32 s37, s101, 86016
    buffer_load_dwordx4 v200, s[24:27], s37 offen offset:0  lds
    v_accvgpr_read_b32 v66, a66
    v_accvgpr_read_b32 v67, a67
    v_accvgpr_read_b32 v68, a68
    v_accvgpr_read_b32 v69, a69
    v_accvgpr_read_b32 v70, a70
    v_accvgpr_read_b32 v71, a71
    v_mul_f32 v64, v64, v242
    v_mul_f32 v65, v65, v242
    v_mul_f32 v66, v66, v242
    v_mul_f32 v67, v67, v242
    v_mul_f32 v68, v68, v242
    v_mul_f32 v69, v69, v242
    v_mul_f32 v70, v70, v242
    v_mul_f32 v71, v71, v242
    v_cvt_pk_bf16_f32 v72, v64, v65
    buffer_load_dwordx4 v201, s[24:27], s37 offen offset:1024  lds
    v_cvt_pk_bf16_f32 v73, v66, v67
    v_cvt_pk_bf16_f32 v74, v68, v69
    v_cvt_pk_bf16_f32 v75, v70, v71
    ds_write_b128 v215, v[72:75] offset:16384
    v_accvgpr_read_b32 v80, a80
    v_accvgpr_read_b32 v81, a81
    v_accvgpr_read_b32 v82, a82
    v_accvgpr_read_b32 v83, a83
    v_accvgpr_read_b32 v84, a84
    v_accvgpr_read_b32 v85, a85
    v_accvgpr_read_b32 v86, a86
    v_accvgpr_read_b32 v87, a87
    v_mul_f32 v80, v80, v243
    v_mul_f32 v81, v81, v243
    v_mul_f32 v82, v82, v243
    buffer_load_dwordx4 v202, s[24:27], s37 offen offset:2048  lds
    v_mul_f32 v83, v83, v243
    v_mul_f32 v84, v84, v243
    v_mul_f32 v85, v85, v243
    v_mul_f32 v86, v86, v243
    v_mul_f32 v87, v87, v243
    v_cvt_pk_bf16_f32 v88, v80, v81
    v_cvt_pk_bf16_f32 v89, v82, v83
    v_cvt_pk_bf16_f32 v90, v84, v85
    v_cvt_pk_bf16_f32 v91, v86, v87
    ds_write_b128 v215, v[88:91] offset:32768
    v_xor_b32 v215, 96, v214
    v_accvgpr_read_b32 v48, a56
    v_accvgpr_read_b32 v49, a57
    v_accvgpr_read_b32 v50, a58
    buffer_load_dwordx4 v203, s[24:27], s37 offen offset:3072  lds
    v_accvgpr_read_b32 v51, a59
    v_accvgpr_read_b32 v52, a60
    v_accvgpr_read_b32 v53, a61
    v_accvgpr_read_b32 v54, a62
    v_accvgpr_read_b32 v55, a63
    v_mul_f32 v48, v48, v241
    v_mul_f32 v49, v49, v241
    v_mul_f32 v50, v50, v241
    v_mul_f32 v51, v51, v241
    v_mul_f32 v52, v52, v241
    v_mul_f32 v53, v53, v241
    v_mul_f32 v54, v54, v241
    v_mul_f32 v55, v55, v241
    v_cvt_pk_bf16_f32 v56, v48, v49
    v_cvt_pk_bf16_f32 v57, v50, v51
    s_add_u32 m0, s32, 18432
    s_add_u32 s37, s101, 86016
    buffer_load_dwordx4 v204, s[24:27], s37 offen offset:0  lds
    v_cvt_pk_bf16_f32 v58, v52, v53
    v_cvt_pk_bf16_f32 v59, v54, v55
    ds_write_b128 v215, v[56:59] offset:0
    v_accvgpr_read_b32 v64, a72
    v_accvgpr_read_b32 v65, a73
    v_accvgpr_read_b32 v66, a74
    v_accvgpr_read_b32 v67, a75
    v_accvgpr_read_b32 v68, a76
    v_accvgpr_read_b32 v69, a77
    v_accvgpr_read_b32 v70, a78
    v_accvgpr_read_b32 v71, a79
    v_mul_f32 v64, v64, v242
    v_mul_f32 v65, v65, v242
    v_mul_f32 v66, v66, v242
    v_mul_f32 v67, v67, v242
    buffer_load_dwordx4 v205, s[24:27], s37 offen offset:1024  lds
    v_mul_f32 v68, v68, v242
    v_mul_f32 v69, v69, v242
    v_mul_f32 v70, v70, v242
    v_mul_f32 v71, v71, v242
    v_cvt_pk_bf16_f32 v72, v64, v65
    v_cvt_pk_bf16_f32 v73, v66, v67
    v_cvt_pk_bf16_f32 v74, v68, v69
    v_cvt_pk_bf16_f32 v75, v70, v71
    ds_write_b128 v215, v[72:75] offset:16384
    v_accvgpr_read_b32 v80, a88
    v_accvgpr_read_b32 v81, a89
    v_accvgpr_read_b32 v82, a90
    v_accvgpr_read_b32 v83, a91
    v_accvgpr_read_b32 v84, a92
    v_accvgpr_read_b32 v85, a93
    buffer_load_dwordx4 v206, s[24:27], s37 offen offset:2048  lds
    v_accvgpr_read_b32 v86, a94
    v_accvgpr_read_b32 v87, a95
    v_mul_f32 v80, v80, v243
    v_mul_f32 v81, v81, v243
    v_mul_f32 v82, v82, v243
    v_mul_f32 v83, v83, v243
    v_mul_f32 v84, v84, v243
    v_mul_f32 v85, v85, v243
    v_mul_f32 v86, v86, v243
    v_mul_f32 v87, v87, v243
    v_cvt_pk_bf16_f32 v88, v80, v81
    v_cvt_pk_bf16_f32 v89, v82, v83
    v_cvt_pk_bf16_f32 v90, v84, v85
    v_cvt_pk_bf16_f32 v91, v86, v87
    ds_write_b128 v215, v[88:91] offset:32768
    s_waitcnt lgkmcnt(0)
    s_barrier
    v_lshlrev_b32 v216, 4, v255
    s_mul_i32 s39, s3, 21504
    ds_read_b128 a[48:51], v209 offset:0
    ds_read_b128 a[52:55], v209 offset:8192
    ds_read_b128 a[56:59], v209 offset:16384
    ds_read_b128 a[60:63], v209 offset:24576
    ds_read_b128 a[64:67], v209 offset:32768
    ds_read_b128 a[68:71], v209 offset:40960
    s_waitcnt lgkmcnt(5)
    v_mfma_f32_16x16x32_bf16 v[0:3], a[0:3], a[48:51], 0
    s_add_u32 m0, s32, 21504
    s_add_u32 s37, s58, 0
    buffer_load_dwordx4 v200, s[24:27], s37 offen offset:0  lds
    ds_read_b128 a[72:75], v210 offset:0
    ds_read_b128 a[76:79], v210 offset:8192
    s_waitcnt lgkmcnt(6)
    v_mfma_f32_16x16x32_bf16 v[12:15], a[0:3], a[52:55], 0
    ds_read_b128 a[80:83], v210 offset:16384
    s_waitcnt lgkmcnt(6)
    v_mfma_f32_16x16x32_bf16 v[24:27], a[0:3], a[56:59], 0
    ds_read_b128 a[84:87], v210 offset:24576
    s_waitcnt lgkmcnt(6)
    v_mfma_f32_16x16x32_bf16 v[36:39], a[0:3], a[60:63], 0
    buffer_load_dwordx4 v201, s[24:27], s37 offen offset:1024  lds
    ds_read_b128 a[88:91], v210 offset:32768
    s_waitcnt lgkmcnt(6)
    v_mfma_f32_16x16x32_bf16 v[48:51], a[0:3], a[64:67], 0
    ds_read_b128 a[92:95], v210 offset:40960
    s_waitcnt lgkmcnt(6)
    v_mfma_f32_16x16x32_bf16 v[60:63], a[0:3], a[68:71], 0
    buffer_load_dwordx4 v202, s[24:27], s37 offen offset:2048  lds
    s_waitcnt vmcnt(17)
    ds_read_b64_tr_b16 a[16:17], v207 offset:0
    v_mfma_f32_16x16x32_bf16 v[4:7], a[4:7], a[48:51], 0
    ds_read_b64_tr_b16 a[18:19], v207 offset:1792
    v_mfma_f32_16x16x32_bf16 v[16:19], a[4:7], a[52:55], 0
    ds_read_b64_tr_b16 a[20:21], v207 offset:32
    v_mfma_f32_16x16x32_bf16 v[28:31], a[4:7], a[56:59], 0
    buffer_load_dwordx4 v203, s[24:27], s37 offen offset:3072  lds
    ds_read_b64_tr_b16 a[22:23], v207 offset:1824
    v_mfma_f32_16x16x32_bf16 v[40:43], a[4:7], a[60:63], 0
    ds_read_b64_tr_b16 a[24:25], v207 offset:64
    ds_read_b64_tr_b16 a[26:27], v207 offset:1856
    v_mfma_f32_16x16x32_bf16 v[52:55], a[4:7], a[64:67], 0
    s_add_u32 m0, s32, 25600
    s_nop 0
    buffer_load_dwordx4 v204, s[24:27], s37 offen offset:0  lds
    ds_read_b64_tr_b16 a[144:145], v207 offset:96
    v_mfma_f32_16x16x32_bf16 v[64:67], a[4:7], a[68:71], 0
    ds_read_b64_tr_b16 a[146:147], v207 offset:1888
    v_mfma_f32_16x16x32_bf16 v[8:11], a[8:11], a[48:51], 0
    ds_read_b64_tr_b16 a[148:149], v207 offset:128
    v_mfma_f32_16x16x32_bf16 v[20:23], a[8:11], a[52:55], 0
    buffer_load_dwordx4 v205, s[24:27], s37 offen offset:1024  lds
    ds_read_b64_tr_b16 a[150:151], v207 offset:1920
    v_mfma_f32_16x16x32_bf16 v[32:35], a[8:11], a[56:59], 0
    ds_read_b64_tr_b16 a[152:153], v207 offset:160
    v_mfma_f32_16x16x32_bf16 v[44:47], a[8:11], a[60:63], 0
    ds_read_b64_tr_b16 a[154:155], v207 offset:1952
    v_mfma_f32_16x16x32_bf16 v[56:59], a[8:11], a[64:67], 0
    buffer_load_dwordx4 v206, s[24:27], s37 offen offset:2048  lds
    ds_read_b64_tr_b16 a[156:157], v207 offset:192
    v_mfma_f32_16x16x32_bf16 v[68:71], a[8:11], a[68:71], 0
    ds_read_b64_tr_b16 a[158:159], v207 offset:1984
    s_waitcnt lgkmcnt(12)
    v_mfma_f32_16x16x32_bf16 v[0:3], a[16:19], a[72:75], v[0:3]
    s_add_u32 m0, s32, 0
    s_add_u32 s37, s58, 28672
    s_waitcnt lgkmcnt(0)
    buffer_load_dwordx4 v200, s[24:27], s37 offen offset:0  lds
    ds_read_b128 a[48:51], v211 offset:0
    ds_read_b128 a[52:55], v211 offset:8192
    v_mfma_f32_16x16x32_bf16 v[12:15], a[16:19], a[76:79], v[12:15]
    ds_read_b128 a[56:59], v211 offset:16384
    v_mfma_f32_16x16x32_bf16 v[24:27], a[16:19], a[80:83], v[24:27]
    ds_read_b128 a[60:63], v211 offset:24576
    v_mfma_f32_16x16x32_bf16 v[36:39], a[16:19], a[84:87], v[36:39]
    buffer_load_dwordx4 v201, s[24:27], s37 offen offset:1024  lds
    ds_read_b128 a[64:67], v211 offset:32768
    v_mfma_f32_16x16x32_bf16 v[48:51], a[16:19], a[88:91], v[48:51]
    ds_read_b128 a[68:71], v211 offset:40960
    v_mfma_f32_16x16x32_bf16 v[60:63], a[16:19], a[92:95], v[60:63]
    buffer_load_dwordx4 v202, s[24:27], s37 offen offset:2048  lds
    s_waitcnt vmcnt(17)
    ds_read_b64_tr_b16 a[0:1], v207 offset:7168
    v_mfma_f32_16x16x32_bf16 v[4:7], a[20:23], a[72:75], v[4:7]
    ds_read_b64_tr_b16 a[2:3], v207 offset:8960
    v_mfma_f32_16x16x32_bf16 v[16:19], a[20:23], a[76:79], v[16:19]
    ds_read_b64_tr_b16 a[4:5], v207 offset:7200
    v_mfma_f32_16x16x32_bf16 v[28:31], a[20:23], a[80:83], v[28:31]
    buffer_load_dwordx4 v203, s[24:27], s37 offen offset:3072  lds
    ds_read_b64_tr_b16 a[6:7], v207 offset:8992
    v_mfma_f32_16x16x32_bf16 v[40:43], a[20:23], a[84:87], v[40:43]
    ds_read_b64_tr_b16 a[8:9], v207 offset:7232
    ds_read_b64_tr_b16 a[10:11], v207 offset:9024
    v_mfma_f32_16x16x32_bf16 v[52:55], a[20:23], a[88:91], v[52:55]
    s_add_u32 m0, s32, 4096
    s_nop 0
    buffer_load_dwordx4 v204, s[24:27], s37 offen offset:0  lds
    ds_read_b64_tr_b16 a[160:161], v207 offset:7264
    v_mfma_f32_16x16x32_bf16 v[64:67], a[20:23], a[92:95], v[64:67]
    ds_read_b64_tr_b16 a[162:163], v207 offset:9056
    v_mfma_f32_16x16x32_bf16 v[8:11], a[24:27], a[72:75], v[8:11]
    ds_read_b64_tr_b16 a[164:165], v207 offset:7296
    v_mfma_f32_16x16x32_bf16 v[20:23], a[24:27], a[76:79], v[20:23]
    buffer_load_dwordx4 v205, s[24:27], s37 offen offset:1024  lds
    ds_read_b64_tr_b16 a[166:167], v207 offset:9088
    v_mfma_f32_16x16x32_bf16 v[32:35], a[24:27], a[80:83], v[32:35]
    ds_read_b64_tr_b16 a[168:169], v207 offset:7328
    v_mfma_f32_16x16x32_bf16 v[44:47], a[24:27], a[84:87], v[44:47]
    ds_read_b64_tr_b16 a[170:171], v207 offset:9120
    v_mfma_f32_16x16x32_bf16 v[56:59], a[24:27], a[88:91], v[56:59]
    buffer_load_dwordx4 v206, s[24:27], s37 offen offset:2048  lds
    ds_read_b64_tr_b16 a[172:173], v207 offset:7360
    v_mfma_f32_16x16x32_bf16 v[68:71], a[24:27], a[92:95], v[68:71]
    ds_read_b64_tr_b16 a[174:175], v207 offset:9152
    s_waitcnt lgkmcnt(12)
    v_mfma_f32_16x16x32_bf16 v[0:3], a[0:3], a[48:51], v[0:3]
    s_add_u32 m0, s32, 7168
    s_add_u32 s37, s58, 57344
    s_waitcnt lgkmcnt(0)
    buffer_load_dwordx4 v200, s[24:27], s37 offen offset:0  lds
    ds_read_b128 a[72:75], v212 offset:0
    ds_read_b128 a[76:79], v212 offset:8192
    v_mfma_f32_16x16x32_bf16 v[12:15], a[0:3], a[52:55], v[12:15]
    ds_read_b128 a[80:83], v212 offset:16384
    v_mfma_f32_16x16x32_bf16 v[24:27], a[0:3], a[56:59], v[24:27]
    ds_read_b128 a[84:87], v212 offset:24576
    v_mfma_f32_16x16x32_bf16 v[36:39], a[0:3], a[60:63], v[36:39]
    buffer_load_dwordx4 v201, s[24:27], s37 offen offset:1024  lds
    ds_read_b128 a[88:91], v212 offset:32768
    v_mfma_f32_16x16x32_bf16 v[48:51], a[0:3], a[64:67], v[48:51]
    ds_read_b128 a[92:95], v212 offset:40960
    v_mfma_f32_16x16x32_bf16 v[60:63], a[0:3], a[68:71], v[60:63]
    buffer_load_dwordx4 v202, s[24:27], s37 offen offset:2048  lds
    s_waitcnt vmcnt(17)
    ds_read_b64_tr_b16 a[16:17], v207 offset:14336
    v_mfma_f32_16x16x32_bf16 v[4:7], a[4:7], a[48:51], v[4:7]
    ds_read_b64_tr_b16 a[18:19], v207 offset:16128
    v_mfma_f32_16x16x32_bf16 v[16:19], a[4:7], a[52:55], v[16:19]
    ds_read_b64_tr_b16 a[20:21], v207 offset:14368
    v_mfma_f32_16x16x32_bf16 v[28:31], a[4:7], a[56:59], v[28:31]
    buffer_load_dwordx4 v203, s[24:27], s37 offen offset:3072  lds
    ds_read_b64_tr_b16 a[22:23], v207 offset:16160
    v_mfma_f32_16x16x32_bf16 v[40:43], a[4:7], a[60:63], v[40:43]
    ds_read_b64_tr_b16 a[24:25], v207 offset:14400
    ds_read_b64_tr_b16 a[26:27], v207 offset:16192
    v_mfma_f32_16x16x32_bf16 v[52:55], a[4:7], a[64:67], v[52:55]
    s_add_u32 m0, s32, 11264
    s_nop 0
    buffer_load_dwordx4 v204, s[24:27], s37 offen offset:0  lds
    ds_read_b64_tr_b16 a[176:177], v207 offset:14432
    v_mfma_f32_16x16x32_bf16 v[64:67], a[4:7], a[68:71], v[64:67]
    ds_read_b64_tr_b16 a[178:179], v207 offset:16224
    v_mfma_f32_16x16x32_bf16 v[8:11], a[8:11], a[48:51], v[8:11]
    ds_read_b64_tr_b16 a[180:181], v207 offset:14464
    v_mfma_f32_16x16x32_bf16 v[20:23], a[8:11], a[52:55], v[20:23]
    buffer_load_dwordx4 v205, s[24:27], s37 offen offset:1024  lds
    ds_read_b64_tr_b16 a[182:183], v207 offset:16256
    v_mfma_f32_16x16x32_bf16 v[32:35], a[8:11], a[56:59], v[32:35]
    ds_read_b64_tr_b16 a[184:185], v207 offset:14496
    v_mfma_f32_16x16x32_bf16 v[44:47], a[8:11], a[60:63], v[44:47]
    ds_read_b64_tr_b16 a[186:187], v207 offset:16288
    v_mfma_f32_16x16x32_bf16 v[56:59], a[8:11], a[64:67], v[56:59]
    buffer_load_dwordx4 v206, s[24:27], s37 offen offset:2048  lds
    ds_read_b64_tr_b16 a[188:189], v207 offset:14528
    v_mfma_f32_16x16x32_bf16 v[68:71], a[8:11], a[68:71], v[68:71]
    ds_read_b64_tr_b16 a[190:191], v207 offset:16320
    s_waitcnt lgkmcnt(12)
    v_mfma_f32_16x16x32_bf16 v[0:3], a[16:19], a[72:75], v[0:3]
    s_add_u32 m0, s32, 14336
    s_add_u32 s37, s58, 86016
    s_waitcnt lgkmcnt(0)
    buffer_load_dwordx4 v200, s[24:27], s37 offen offset:0  lds
    v_xor_b32 v209, 0x100, v209
    v_xor_b32 v210, 0x100, v210
    v_mfma_f32_16x16x32_bf16 v[12:15], a[16:19], a[76:79], v[12:15]
    v_xor_b32 v211, 0x100, v211
    v_mfma_f32_16x16x32_bf16 v[24:27], a[16:19], a[80:83], v[24:27]
    v_xor_b32 v212, 0x100, v212
    v_mfma_f32_16x16x32_bf16 v[36:39], a[16:19], a[84:87], v[36:39]
    buffer_load_dwordx4 v201, s[24:27], s37 offen offset:1024  lds
    ds_read_b128 a[48:51], v209 offset:0
    ds_read_b128 a[52:55], v209 offset:8192
    v_mfma_f32_16x16x32_bf16 v[48:51], a[16:19], a[88:91], v[48:51]
    ds_read_b128 a[56:59], v209 offset:16384
    v_mfma_f32_16x16x32_bf16 v[60:63], a[16:19], a[92:95], v[60:63]
    buffer_load_dwordx4 v202, s[24:27], s37 offen offset:2048  lds
    ds_read_b128 a[60:63], v209 offset:24576
    v_mfma_f32_16x16x32_bf16 v[4:7], a[20:23], a[72:75], v[4:7]
    ds_read_b128 a[64:67], v209 offset:32768
    ds_read_b128 a[68:71], v209 offset:40960
    v_mfma_f32_16x16x32_bf16 v[16:19], a[20:23], a[76:79], v[16:19]
    s_waitcnt vmcnt(17)
    ds_read_b64_tr_b16 a[0:1], v207 offset:21504
    v_mfma_f32_16x16x32_bf16 v[28:31], a[20:23], a[80:83], v[28:31]
    buffer_load_dwordx4 v203, s[24:27], s37 offen offset:3072  lds
    ds_read_b64_tr_b16 a[2:3], v207 offset:23296
    v_mfma_f32_16x16x32_bf16 v[40:43], a[20:23], a[84:87], v[40:43]
    ds_read_b64_tr_b16 a[4:5], v207 offset:21536
    ds_read_b64_tr_b16 a[6:7], v207 offset:23328
    v_mfma_f32_16x16x32_bf16 v[52:55], a[20:23], a[88:91], v[52:55]
    s_add_u32 m0, s32, 18432
    s_nop 0
    buffer_load_dwordx4 v204, s[24:27], s37 offen offset:0  lds
    ds_read_b64_tr_b16 a[8:9], v207 offset:21568
    v_mfma_f32_16x16x32_bf16 v[64:67], a[20:23], a[92:95], v[64:67]
    ds_read_b64_tr_b16 a[10:11], v207 offset:23360
    v_mfma_f32_16x16x32_bf16 v[8:11], a[24:27], a[72:75], v[8:11]
    ds_read_b64_tr_b16 a[192:193], v207 offset:21600
    ds_read_b64_tr_b16 a[194:195], v207 offset:23392
    v_mfma_f32_16x16x32_bf16 v[20:23], a[24:27], a[76:79], v[20:23]
    buffer_load_dwordx4 v205, s[24:27], s37 offen offset:1024  lds
    ds_read_b64_tr_b16 a[196:197], v207 offset:21632
    v_mfma_f32_16x16x32_bf16 v[32:35], a[24:27], a[80:83], v[32:35]
    ds_read_b64_tr_b16 a[198:199], v207 offset:23424
    v_mfma_f32_16x16x32_bf16 v[44:47], a[24:27], a[84:87], v[44:47]
    ds_read_b64_tr_b16 a[200:201], v207 offset:21664
    ds_read_b64_tr_b16 a[202:203], v207 offset:23456
    v_mfma_f32_16x16x32_bf16 v[56:59], a[24:27], a[88:91], v[56:59]
    buffer_load_dwordx4 v206, s[24:27], s37 offen offset:2048  lds
    ds_read_b64_tr_b16 a[204:205], v207 offset:21696
    v_mfma_f32_16x16x32_bf16 v[68:71], a[24:27], a[92:95], v[68:71]
    ds_read_b64_tr_b16 a[206:207], v207 offset:23488
    s_waitcnt lgkmcnt(12)
    v_mfma_f32_16x16x32_bf16 v[0:3], a[0:3], a[48:51], v[0:3]
    ds_read_b128 a[72:75], v210 offset:0
    ds_read_b128 a[76:79], v210 offset:8192
    v_mfma_f32_16x16x32_bf16 v[12:15], a[0:3], a[52:55], v[12:15]
    ds_read_b128 a[80:83], v210 offset:16384
    v_mfma_f32_16x16x32_bf16 v[24:27], a[0:3], a[56:59], v[24:27]
    ds_read_b128 a[84:87], v210 offset:24576
    v_mfma_f32_16x16x32_bf16 v[36:39], a[0:3], a[60:63], v[36:39]
    ds_read_b128 a[88:91], v210 offset:32768
    v_mfma_f32_16x16x32_bf16 v[48:51], a[0:3], a[64:67], v[48:51]
    ds_read_b128 a[92:95], v210 offset:40960
    v_mfma_f32_16x16x32_bf16 v[60:63], a[0:3], a[68:71], v[60:63]
    s_waitcnt vmcnt(14)
    ds_read_b64_tr_b16 a[16:17], v207 offset:0
    s_waitcnt lgkmcnt(15)
    v_mfma_f32_16x16x32_bf16 v[4:7], a[4:7], a[48:51], v[4:7]
    ds_read_b64_tr_b16 a[18:19], v207 offset:1792
    v_mfma_f32_16x16x32_bf16 v[16:19], a[4:7], a[52:55], v[16:19]
    ds_read_b64_tr_b16 a[20:21], v207 offset:32
    v_mfma_f32_16x16x32_bf16 v[28:31], a[4:7], a[56:59], v[28:31]
    ds_read_b64_tr_b16 a[22:23], v207 offset:1824
    v_mfma_f32_16x16x32_bf16 v[40:43], a[4:7], a[60:63], v[40:43]
    ds_read_b64_tr_b16 a[24:25], v207 offset:64
    ds_read_b64_tr_b16 a[26:27], v207 offset:1856
    v_mfma_f32_16x16x32_bf16 v[52:55], a[4:7], a[64:67], v[52:55]
    ds_read_b64_tr_b16 a[208:209], v207 offset:96
    v_mfma_f32_16x16x32_bf16 v[64:67], a[4:7], a[68:71], v[64:67]
    ds_read_b64_tr_b16 a[210:211], v207 offset:1888
    v_mfma_f32_16x16x32_bf16 v[8:11], a[8:11], a[48:51], v[8:11]
    ds_read_b64_tr_b16 a[212:213], v207 offset:128
    v_mfma_f32_16x16x32_bf16 v[20:23], a[8:11], a[52:55], v[20:23]
    ds_read_b64_tr_b16 a[214:215], v207 offset:1920
    v_mfma_f32_16x16x32_bf16 v[32:35], a[8:11], a[56:59], v[32:35]
    ds_read_b64_tr_b16 a[216:217], v207 offset:160
    v_mfma_f32_16x16x32_bf16 v[44:47], a[8:11], a[60:63], v[44:47]
    ds_read_b64_tr_b16 a[218:219], v207 offset:1952
    v_mfma_f32_16x16x32_bf16 v[56:59], a[8:11], a[64:67], v[56:59]
    ds_read_b64_tr_b16 a[220:221], v207 offset:192
    v_mfma_f32_16x16x32_bf16 v[68:71], a[8:11], a[68:71], v[68:71]
    ds_read_b64_tr_b16 a[222:223], v207 offset:1984
    s_waitcnt lgkmcnt(12)
    v_mfma_f32_16x16x32_bf16 v[0:3], a[16:19], a[72:75], v[0:3]
    ds_read_b128 a[48:51], v211 offset:0
    ds_read_b128 a[52:55], v211 offset:8192
    v_mfma_f32_16x16x32_bf16 v[12:15], a[16:19], a[76:79], v[12:15]
    ds_read_b128 a[56:59], v211 offset:16384
    v_mfma_f32_16x16x32_bf16 v[24:27], a[16:19], a[80:83], v[24:27]
    ds_read_b128 a[60:63], v211 offset:24576
    v_mfma_f32_16x16x32_bf16 v[36:39], a[16:19], a[84:87], v[36:39]
    ds_read_b128 a[64:67], v211 offset:32768
    v_mfma_f32_16x16x32_bf16 v[48:51], a[16:19], a[88:91], v[48:51]
    ds_read_b128 a[68:71], v211 offset:40960
    v_mfma_f32_16x16x32_bf16 v[60:63], a[16:19], a[92:95], v[60:63]
    s_waitcnt vmcnt(7)
    ds_read_b64_tr_b16 a[0:1], v207 offset:7168
    s_waitcnt lgkmcnt(15)
    v_mfma_f32_16x16x32_bf16 v[4:7], a[20:23], a[72:75], v[4:7]
    ds_read_b64_tr_b16 a[2:3], v207 offset:8960
    v_mfma_f32_16x16x32_bf16 v[16:19], a[20:23], a[76:79], v[16:19]
    ds_read_b64_tr_b16 a[4:5], v207 offset:7200
    v_mfma_f32_16x16x32_bf16 v[28:31], a[20:23], a[80:83], v[28:31]
    ds_read_b64_tr_b16 a[6:7], v207 offset:8992
    v_mfma_f32_16x16x32_bf16 v[40:43], a[20:23], a[84:87], v[40:43]
    ds_read_b64_tr_b16 a[8:9], v207 offset:7232
    ds_read_b64_tr_b16 a[10:11], v207 offset:9024
    v_mfma_f32_16x16x32_bf16 v[52:55], a[20:23], a[88:91], v[52:55]
    ds_read_b64_tr_b16 a[224:225], v207 offset:7264
    v_mfma_f32_16x16x32_bf16 v[64:67], a[20:23], a[92:95], v[64:67]
    ds_read_b64_tr_b16 a[226:227], v207 offset:9056
    v_mfma_f32_16x16x32_bf16 v[8:11], a[24:27], a[72:75], v[8:11]
    ds_read_b64_tr_b16 a[228:229], v207 offset:7296
    v_mfma_f32_16x16x32_bf16 v[20:23], a[24:27], a[76:79], v[20:23]
    ds_read_b64_tr_b16 a[230:231], v207 offset:9088
    v_mfma_f32_16x16x32_bf16 v[32:35], a[24:27], a[80:83], v[32:35]
    ds_read_b64_tr_b16 a[232:233], v207 offset:7328
    v_mfma_f32_16x16x32_bf16 v[44:47], a[24:27], a[84:87], v[44:47]
    ds_read_b64_tr_b16 a[234:235], v207 offset:9120
    v_mfma_f32_16x16x32_bf16 v[56:59], a[24:27], a[88:91], v[56:59]
    ds_read_b64_tr_b16 a[236:237], v207 offset:7360
    v_mfma_f32_16x16x32_bf16 v[68:71], a[24:27], a[92:95], v[68:71]
    ds_read_b64_tr_b16 a[238:239], v207 offset:9152
    s_waitcnt lgkmcnt(12)
    v_mfma_f32_16x16x32_bf16 v[0:3], a[0:3], a[48:51], v[0:3]
    ds_read_b128 a[72:75], v212 offset:0
    ds_read_b128 a[76:79], v212 offset:8192
    v_mfma_f32_16x16x32_bf16 v[12:15], a[0:3], a[52:55], v[12:15]
    ds_read_b128 a[80:83], v212 offset:16384
    v_mfma_f32_16x16x32_bf16 v[24:27], a[0:3], a[56:59], v[24:27]
    ds_read_b128 a[84:87], v212 offset:24576
    v_mfma_f32_16x16x32_bf16 v[36:39], a[0:3], a[60:63], v[36:39]
    ds_read_b128 a[88:91], v212 offset:32768
    v_mfma_f32_16x16x32_bf16 v[48:51], a[0:3], a[64:67], v[48:51]
    ds_read_b128 a[92:95], v212 offset:40960
    v_mfma_f32_16x16x32_bf16 v[60:63], a[0:3], a[68:71], v[60:63]
    s_waitcnt vmcnt(0)
    ds_read_b64_tr_b16 a[16:17], v207 offset:14336
    s_waitcnt lgkmcnt(15)
    v_mfma_f32_16x16x32_bf16 v[4:7], a[4:7], a[48:51], v[4:7]
    ds_read_b64_tr_b16 a[18:19], v207 offset:16128
    v_mfma_f32_16x16x32_bf16 v[16:19], a[4:7], a[52:55], v[16:19]
    ds_read_b64_tr_b16 a[20:21], v207 offset:14368
    v_mfma_f32_16x16x32_bf16 v[28:31], a[4:7], a[56:59], v[28:31]
    ds_read_b64_tr_b16 a[22:23], v207 offset:16160
    v_mfma_f32_16x16x32_bf16 v[40:43], a[4:7], a[60:63], v[40:43]
    ds_read_b64_tr_b16 a[24:25], v207 offset:14400
    ds_read_b64_tr_b16 a[26:27], v207 offset:16192
    v_mfma_f32_16x16x32_bf16 v[52:55], a[4:7], a[64:67], v[52:55]
    ds_read_b64_tr_b16 a[240:241], v207 offset:14432
    v_mfma_f32_16x16x32_bf16 v[64:67], a[4:7], a[68:71], v[64:67]
    ds_read_b64_tr_b16 a[242:243], v207 offset:16224
    v_mfma_f32_16x16x32_bf16 v[8:11], a[8:11], a[48:51], v[8:11]
    ds_read_b64_tr_b16 a[244:245], v207 offset:14464
    v_mfma_f32_16x16x32_bf16 v[20:23], a[8:11], a[52:55], v[20:23]
    ds_read_b64_tr_b16 a[246:247], v207 offset:16256
    v_mfma_f32_16x16x32_bf16 v[32:35], a[8:11], a[56:59], v[32:35]
    ds_read_b64_tr_b16 a[248:249], v207 offset:14496
    v_mfma_f32_16x16x32_bf16 v[44:47], a[8:11], a[60:63], v[44:47]
    ds_read_b64_tr_b16 a[250:251], v207 offset:16288
    v_mfma_f32_16x16x32_bf16 v[56:59], a[8:11], a[64:67], v[56:59]
    ds_read_b64_tr_b16 a[252:253], v207 offset:14528
    v_mfma_f32_16x16x32_bf16 v[68:71], a[8:11], a[68:71], v[68:71]
    ds_read_b64_tr_b16 a[254:255], v207 offset:16320
    s_waitcnt lgkmcnt(12)
    v_mfma_f32_16x16x32_bf16 v[0:3], a[16:19], a[72:75], v[0:3]
    v_xor_b32 v209, 0x100, v209
    v_mfma_f32_16x16x32_bf16 v[12:15], a[16:19], a[76:79], v[12:15]
    v_xor_b32 v210, 0x100, v210
    v_mfma_f32_16x16x32_bf16 v[24:27], a[16:19], a[80:83], v[24:27]
    v_mfma_f32_16x16x32_bf16 v[36:39], a[16:19], a[84:87], v[36:39]
    v_xor_b32 v211, 0x100, v211
    v_mfma_f32_16x16x32_bf16 v[48:51], a[16:19], a[88:91], v[48:51]
    v_mfma_f32_16x16x32_bf16 v[60:63], a[16:19], a[92:95], v[60:63]
    v_xor_b32 v212, 0x100, v212
    s_waitcnt lgkmcnt(10)
    v_mfma_f32_16x16x32_bf16 v[4:7], a[20:23], a[72:75], v[4:7]
    v_mfma_f32_16x16x32_bf16 v[16:19], a[20:23], a[76:79], v[16:19]
    ds_read_b128 a[48:51], v209 offset:0
    v_mfma_f32_16x16x32_bf16 v[28:31], a[20:23], a[80:83], v[28:31]
    v_mfma_f32_16x16x32_bf16 v[40:43], a[20:23], a[84:87], v[40:43]
    ds_read_b128 a[52:55], v209 offset:8192
    v_mfma_f32_16x16x32_bf16 v[52:55], a[20:23], a[88:91], v[52:55]
    ds_read_b128 a[56:59], v209 offset:16384
    v_mfma_f32_16x16x32_bf16 v[64:67], a[20:23], a[92:95], v[64:67]
    s_waitcnt lgkmcnt(11)
    v_mfma_f32_16x16x32_bf16 v[8:11], a[24:27], a[72:75], v[8:11]
    ds_read_b128 a[60:63], v209 offset:24576
    v_mfma_f32_16x16x32_bf16 v[20:23], a[24:27], a[76:79], v[20:23]
    v_mfma_f32_16x16x32_bf16 v[32:35], a[24:27], a[80:83], v[32:35]
    ds_read_b128 a[64:67], v209 offset:32768
    v_mfma_f32_16x16x32_bf16 v[44:47], a[24:27], a[84:87], v[44:47]
    v_mfma_f32_16x16x32_bf16 v[56:59], a[24:27], a[88:91], v[56:59]
    ds_read_b128 a[68:71], v209 offset:40960
    v_mfma_f32_16x16x32_bf16 v[68:71], a[24:27], a[92:95], v[68:71]
    s_waitcnt lgkmcnt(5)
    v_mfma_f32_16x16x32_bf16 v[72:75], a[128:131], a[48:51], 0
    v_cvt_pk_bf16_f32 v0, v0, v1
    v_cvt_pk_bf16_f32 v1, v2, v3
    v_cvt_pk_bf16_f32 v2, v4, v5
    v_cvt_pk_bf16_f32 v3, v6, v7
    s_add_u32 s54, s39, 0
    buffer_store_dwordx4 v[0:3], v216, s[28:31], s54 offen offset:0 sc1
    ds_read_b128 a[72:75], v210 offset:0
    s_waitcnt lgkmcnt(5)
    v_mfma_f32_16x16x32_bf16 v[80:83], a[128:131], a[52:55], 0
    s_waitcnt lgkmcnt(4)
    v_mfma_f32_16x16x32_bf16 v[88:91], a[128:131], a[56:59], 0
    ds_read_b128 a[76:79], v210 offset:8192
    s_waitcnt lgkmcnt(4)
    v_mfma_f32_16x16x32_bf16 v[96:99], a[128:131], a[60:63], 0
    v_cvt_pk_bf16_f32 v8, v8, v9
    v_cvt_pk_bf16_f32 v9, v10, v11
    v_cvt_pk_bf16_f32 v10, v12, v13
    v_cvt_pk_bf16_f32 v11, v14, v15
    s_add_u32 s54, s39, 0
    buffer_store_dwordx4 v[8:11], v216, s[28:31], s54 offen offset:1024 sc1
    s_waitcnt lgkmcnt(3)
    v_mfma_f32_16x16x32_bf16 v[104:107], a[128:131], a[64:67], 0
    ds_read_b128 a[80:83], v210 offset:16384
    s_waitcnt lgkmcnt(3)
    v_mfma_f32_16x16x32_bf16 v[112:115], a[128:131], a[68:71], 0
    v_mfma_f32_16x16x32_bf16 v[76:79], a[132:135], a[48:51], 0
    v_cvt_pk_bf16_f32 v16, v16, v17
    v_cvt_pk_bf16_f32 v17, v18, v19
    v_cvt_pk_bf16_f32 v18, v20, v21
    v_cvt_pk_bf16_f32 v19, v22, v23
    s_add_u32 s54, s39, 0
    buffer_store_dwordx4 v[16:19], v216, s[28:31], s54 offen offset:2048 sc1
    ds_read_b128 a[84:87], v210 offset:24576
    v_mfma_f32_16x16x32_bf16 v[84:87], a[132:135], a[52:55], 0
    v_mfma_f32_16x16x32_bf16 v[92:95], a[132:135], a[56:59], 0
    ds_read_b128 a[88:91], v210 offset:32768
    v_mfma_f32_16x16x32_bf16 v[100:103], a[132:135], a[60:63], 0
    v_cvt_pk_bf16_f32 v24, v24, v25
    v_cvt_pk_bf16_f32 v25, v26, v27
    v_cvt_pk_bf16_f32 v26, v28, v29
    v_cvt_pk_bf16_f32 v27, v30, v31
    s_add_u32 s54, s39, 0
    buffer_store_dwordx4 v[24:27], v216, s[28:31], s54 offen offset:3072 sc1
    v_cvt_pk_bf16_f32 v32, v32, v33
    v_cvt_pk_bf16_f32 v33, v34, v35
    v_cvt_pk_bf16_f32 v34, v36, v37
    v_mfma_f32_16x16x32_bf16 v[108:111], a[132:135], a[64:67], 0
    ds_read_b128 a[92:95], v210 offset:40960
    v_mfma_f32_16x16x32_bf16 v[116:119], a[132:135], a[68:71], 0
    s_waitcnt lgkmcnt(5)
    v_mfma_f32_16x16x32_bf16 v[72:75], a[144:147], a[72:75], v[72:75]
    v_cvt_pk_bf16_f32 v35, v38, v39
    s_add_u32 s54, s39, 4096
    buffer_store_dwordx4 v[32:35], v216, s[28:31], s54 offen offset:0 sc1
    ds_read_b128 a[48:51], v211 offset:0
    s_waitcnt lgkmcnt(5)
    v_mfma_f32_16x16x32_bf16 v[80:83], a[144:147], a[76:79], v[80:83]
    s_waitcnt lgkmcnt(4)
    v_mfma_f32_16x16x32_bf16 v[88:91], a[144:147], a[80:83], v[88:91]
    ds_read_b128 a[52:55], v211 offset:8192
    s_waitcnt lgkmcnt(4)
    v_mfma_f32_16x16x32_bf16 v[96:99], a[144:147], a[84:87], v[96:99]
    v_cvt_pk_bf16_f32 v40, v40, v41
    v_cvt_pk_bf16_f32 v41, v42, v43
    v_cvt_pk_bf16_f32 v42, v44, v45
    v_cvt_pk_bf16_f32 v43, v46, v47
    s_add_u32 s54, s39, 4096
    buffer_store_dwordx4 v[40:43], v216, s[28:31], s54 offen offset:1024 sc1
    s_waitcnt lgkmcnt(3)
    v_mfma_f32_16x16x32_bf16 v[104:107], a[144:147], a[88:91], v[104:107]
    ds_read_b128 a[56:59], v211 offset:16384
    s_waitcnt lgkmcnt(3)
    v_mfma_f32_16x16x32_bf16 v[112:115], a[144:147], a[92:95], v[112:115]
    v_cvt_pk_bf16_f32 v48, v48, v49
    v_cvt_pk_bf16_f32 v49, v50, v51
    v_cvt_pk_bf16_f32 v50, v52, v53
    v_cvt_pk_bf16_f32 v51, v54, v55
    s_add_u32 s54, s39, 4096
    buffer_store_dwordx4 v[48:51], v216, s[28:31], s54 offen offset:2048 sc1
    v_mfma_f32_16x16x32_bf16 v[76:79], a[148:151], a[72:75], v[76:79]
    ds_read_b128 a[60:63], v211 offset:24576
    v_mfma_f32_16x16x32_bf16 v[84:87], a[148:151], a[76:79], v[84:87]
    v_cvt_pk_bf16_f32 v56, v56, v57
    v_cvt_pk_bf16_f32 v57, v58, v59
    v_cvt_pk_bf16_f32 v58, v60, v61
    v_cvt_pk_bf16_f32 v59, v62, v63
    s_add_u32 s54, s39, 4096
    buffer_store_dwordx4 v[56:59], v216, s[28:31], s54 offen offset:3072 sc1
    v_mfma_f32_16x16x32_bf16 v[92:95], a[148:151], a[80:83], v[92:95]
    ds_read_b128 a[64:67], v211 offset:32768
    v_mfma_f32_16x16x32_bf16 v[100:103], a[148:151], a[84:87], v[100:103]
    v_mfma_f32_16x16x32_bf16 v[108:111], a[148:151], a[88:91], v[108:111]
    v_cvt_pk_bf16_f32 v64, v64, v65
    v_cvt_pk_bf16_f32 v65, v66, v67
    v_cvt_pk_bf16_f32 v66, v68, v69
    v_cvt_pk_bf16_f32 v67, v70, v71
    s_add_u32 s54, s39, 8192
    buffer_store_dwordx4 v[64:67], v216, s[28:31], s54 offen offset:0 sc1
    ds_read_b128 a[68:71], v211 offset:40960
    v_mfma_f32_16x16x32_bf16 v[116:119], a[148:151], a[92:95], v[116:119]
    s_waitcnt lgkmcnt(5)
    v_mfma_f32_16x16x32_bf16 v[72:75], a[160:163], a[48:51], v[72:75]
    ds_read_b128 a[72:75], v212 offset:0
    s_waitcnt lgkmcnt(5)
    v_mfma_f32_16x16x32_bf16 v[80:83], a[160:163], a[52:55], v[80:83]
    s_waitcnt lgkmcnt(4)
    v_mfma_f32_16x16x32_bf16 v[88:91], a[160:163], a[56:59], v[88:91]
    ds_read_b128 a[76:79], v212 offset:8192
    s_waitcnt lgkmcnt(4)
    v_mfma_f32_16x16x32_bf16 v[96:99], a[160:163], a[60:63], v[96:99]
    s_waitcnt lgkmcnt(3)
    v_mfma_f32_16x16x32_bf16 v[104:107], a[160:163], a[64:67], v[104:107]
    ds_read_b128 a[80:83], v212 offset:16384
    s_waitcnt lgkmcnt(3)
    v_mfma_f32_16x16x32_bf16 v[112:115], a[160:163], a[68:71], v[112:115]
    v_mfma_f32_16x16x32_bf16 v[76:79], a[164:167], a[48:51], v[76:79]
    ds_read_b128 a[84:87], v212 offset:24576
    v_mfma_f32_16x16x32_bf16 v[84:87], a[164:167], a[52:55], v[84:87]
    v_mfma_f32_16x16x32_bf16 v[92:95], a[164:167], a[56:59], v[92:95]
    ds_read_b128 a[88:91], v212 offset:32768
    v_mfma_f32_16x16x32_bf16 v[100:103], a[164:167], a[60:63], v[100:103]
    v_mfma_f32_16x16x32_bf16 v[108:111], a[164:167], a[64:67], v[108:111]
    ds_read_b128 a[92:95], v212 offset:40960
    v_mfma_f32_16x16x32_bf16 v[116:119], a[164:167], a[68:71], v[116:119]
    s_waitcnt lgkmcnt(5)
    v_mfma_f32_16x16x32_bf16 v[72:75], a[176:179], a[72:75], v[72:75]
    v_xor_b32 v209, 0x100, v209
    s_waitcnt lgkmcnt(4)
    v_mfma_f32_16x16x32_bf16 v[80:83], a[176:179], a[76:79], v[80:83]
    v_xor_b32 v210, 0x100, v210
    s_waitcnt lgkmcnt(3)
    v_mfma_f32_16x16x32_bf16 v[88:91], a[176:179], a[80:83], v[88:91]
    v_xor_b32 v211, 0x100, v211
    s_waitcnt lgkmcnt(2)
    v_mfma_f32_16x16x32_bf16 v[96:99], a[176:179], a[84:87], v[96:99]
    v_xor_b32 v212, 0x100, v212
    s_waitcnt lgkmcnt(1)
    v_mfma_f32_16x16x32_bf16 v[104:107], a[176:179], a[88:91], v[104:107]
    ds_read_b128 a[48:51], v209 offset:0
    s_waitcnt lgkmcnt(1)
    v_mfma_f32_16x16x32_bf16 v[112:115], a[176:179], a[92:95], v[112:115]
    v_mfma_f32_16x16x32_bf16 v[76:79], a[180:183], a[72:75], v[76:79]
    ds_read_b128 a[52:55], v209 offset:8192
    v_mfma_f32_16x16x32_bf16 v[84:87], a[180:183], a[76:79], v[84:87]
    ds_read_b128 a[56:59], v209 offset:16384
    v_mfma_f32_16x16x32_bf16 v[92:95], a[180:183], a[80:83], v[92:95]
    ds_read_b128 a[60:63], v209 offset:24576
    v_mfma_f32_16x16x32_bf16 v[100:103], a[180:183], a[84:87], v[100:103]
    ds_read_b128 a[64:67], v209 offset:32768
    v_mfma_f32_16x16x32_bf16 v[108:111], a[180:183], a[88:91], v[108:111]
    ds_read_b128 a[68:71], v209 offset:40960
    v_mfma_f32_16x16x32_bf16 v[116:119], a[180:183], a[92:95], v[116:119]
    s_waitcnt lgkmcnt(5)
    v_mfma_f32_16x16x32_bf16 v[72:75], a[192:195], a[48:51], v[72:75]
    ds_read_b128 a[72:75], v210 offset:0
    s_waitcnt lgkmcnt(5)
    v_mfma_f32_16x16x32_bf16 v[80:83], a[192:195], a[52:55], v[80:83]
    s_waitcnt lgkmcnt(4)
    v_mfma_f32_16x16x32_bf16 v[88:91], a[192:195], a[56:59], v[88:91]
    ds_read_b128 a[76:79], v210 offset:8192
    s_waitcnt lgkmcnt(4)
    v_mfma_f32_16x16x32_bf16 v[96:99], a[192:195], a[60:63], v[96:99]
    s_waitcnt lgkmcnt(3)
    v_mfma_f32_16x16x32_bf16 v[104:107], a[192:195], a[64:67], v[104:107]
    ds_read_b128 a[80:83], v210 offset:16384
    s_waitcnt lgkmcnt(3)
    v_mfma_f32_16x16x32_bf16 v[112:115], a[192:195], a[68:71], v[112:115]
    v_mfma_f32_16x16x32_bf16 v[76:79], a[196:199], a[48:51], v[76:79]
    ds_read_b128 a[84:87], v210 offset:24576
    v_mfma_f32_16x16x32_bf16 v[84:87], a[196:199], a[52:55], v[84:87]
    v_mfma_f32_16x16x32_bf16 v[92:95], a[196:199], a[56:59], v[92:95]
    ds_read_b128 a[88:91], v210 offset:32768
    v_mfma_f32_16x16x32_bf16 v[100:103], a[196:199], a[60:63], v[100:103]
    v_mfma_f32_16x16x32_bf16 v[108:111], a[196:199], a[64:67], v[108:111]
    ds_read_b128 a[92:95], v210 offset:40960
    v_mfma_f32_16x16x32_bf16 v[116:119], a[196:199], a[68:71], v[116:119]
    s_waitcnt lgkmcnt(5)
    v_mfma_f32_16x16x32_bf16 v[72:75], a[208:211], a[72:75], v[72:75]
    ds_read_b128 a[48:51], v211 offset:0
    s_waitcnt lgkmcnt(5)
    v_mfma_f32_16x16x32_bf16 v[80:83], a[208:211], a[76:79], v[80:83]
    s_waitcnt lgkmcnt(4)
    v_mfma_f32_16x16x32_bf16 v[88:91], a[208:211], a[80:83], v[88:91]
    ds_read_b128 a[52:55], v211 offset:8192
    s_waitcnt lgkmcnt(4)
    v_mfma_f32_16x16x32_bf16 v[96:99], a[208:211], a[84:87], v[96:99]
    s_waitcnt lgkmcnt(3)
    v_mfma_f32_16x16x32_bf16 v[104:107], a[208:211], a[88:91], v[104:107]
    ds_read_b128 a[56:59], v211 offset:16384
    s_waitcnt lgkmcnt(3)
    v_mfma_f32_16x16x32_bf16 v[112:115], a[208:211], a[92:95], v[112:115]
    v_mfma_f32_16x16x32_bf16 v[76:79], a[212:215], a[72:75], v[76:79]
    ds_read_b128 a[60:63], v211 offset:24576
    v_mfma_f32_16x16x32_bf16 v[84:87], a[212:215], a[76:79], v[84:87]
    v_mfma_f32_16x16x32_bf16 v[92:95], a[212:215], a[80:83], v[92:95]
    ds_read_b128 a[64:67], v211 offset:32768
    v_mfma_f32_16x16x32_bf16 v[100:103], a[212:215], a[84:87], v[100:103]
    v_mfma_f32_16x16x32_bf16 v[108:111], a[212:215], a[88:91], v[108:111]
    ds_read_b128 a[68:71], v211 offset:40960
    v_mfma_f32_16x16x32_bf16 v[116:119], a[212:215], a[92:95], v[116:119]
    s_waitcnt lgkmcnt(5)
    v_mfma_f32_16x16x32_bf16 v[72:75], a[224:227], a[48:51], v[72:75]
    ds_read_b128 a[72:75], v212 offset:0
    s_waitcnt lgkmcnt(5)
    v_mfma_f32_16x16x32_bf16 v[80:83], a[224:227], a[52:55], v[80:83]
    s_waitcnt lgkmcnt(4)
    v_mfma_f32_16x16x32_bf16 v[88:91], a[224:227], a[56:59], v[88:91]
    ds_read_b128 a[76:79], v212 offset:8192
    s_waitcnt lgkmcnt(4)
    v_mfma_f32_16x16x32_bf16 v[96:99], a[224:227], a[60:63], v[96:99]
    s_waitcnt lgkmcnt(3)
    v_mfma_f32_16x16x32_bf16 v[104:107], a[224:227], a[64:67], v[104:107]
    ds_read_b128 a[80:83], v212 offset:16384
    s_waitcnt lgkmcnt(3)
    v_mfma_f32_16x16x32_bf16 v[112:115], a[224:227], a[68:71], v[112:115]
    v_mfma_f32_16x16x32_bf16 v[76:79], a[228:231], a[48:51], v[76:79]
    ds_read_b128 a[84:87], v212 offset:24576
    v_mfma_f32_16x16x32_bf16 v[84:87], a[228:231], a[52:55], v[84:87]
    v_mfma_f32_16x16x32_bf16 v[92:95], a[228:231], a[56:59], v[92:95]
    ds_read_b128 a[88:91], v212 offset:32768
    v_mfma_f32_16x16x32_bf16 v[100:103], a[228:231], a[60:63], v[100:103]
    v_mfma_f32_16x16x32_bf16 v[108:111], a[228:231], a[64:67], v[108:111]
    ds_read_b128 a[92:95], v212 offset:40960
    v_mfma_f32_16x16x32_bf16 v[116:119], a[228:231], a[68:71], v[116:119]
    s_waitcnt lgkmcnt(5)
    v_mfma_f32_16x16x32_bf16 v[72:75], a[240:243], a[72:75], v[72:75]
    v_xor_b32 v209, 0x100, v209
    s_waitcnt lgkmcnt(4)
    v_mfma_f32_16x16x32_bf16 v[80:83], a[240:243], a[76:79], v[80:83]
    v_xor_b32 v210, 0x100, v210
    s_waitcnt lgkmcnt(3)
    v_mfma_f32_16x16x32_bf16 v[88:91], a[240:243], a[80:83], v[88:91]
    v_xor_b32 v211, 0x100, v211
    s_waitcnt lgkmcnt(2)
    v_mfma_f32_16x16x32_bf16 v[96:99], a[240:243], a[84:87], v[96:99]
    v_xor_b32 v212, 0x100, v212
    s_waitcnt lgkmcnt(1)
    v_mfma_f32_16x16x32_bf16 v[104:107], a[240:243], a[88:91], v[104:107]
    ds_read_b128 a[48:51], v209 offset:0
    s_waitcnt lgkmcnt(1)
    v_mfma_f32_16x16x32_bf16 v[112:115], a[240:243], a[92:95], v[112:115]
    v_mfma_f32_16x16x32_bf16 v[76:79], a[244:247], a[72:75], v[76:79]
    ds_read_b128 a[52:55], v209 offset:8192
    v_mfma_f32_16x16x32_bf16 v[84:87], a[244:247], a[76:79], v[84:87]
    ds_read_b128 a[56:59], v209 offset:16384
    v_mfma_f32_16x16x32_bf16 v[92:95], a[244:247], a[80:83], v[92:95]
    ds_read_b128 a[60:63], v209 offset:24576
    v_mfma_f32_16x16x32_bf16 v[100:103], a[244:247], a[84:87], v[100:103]
    ds_read_b128 a[64:67], v209 offset:32768
    v_mfma_f32_16x16x32_bf16 v[108:111], a[244:247], a[88:91], v[108:111]
    ds_read_b128 a[68:71], v209 offset:40960
    v_mfma_f32_16x16x32_bf16 v[116:119], a[244:247], a[92:95], v[116:119]
    s_getpc_b64 s[54:55]
L_pc2:
    s_add_u32 s54, s54, gqa_reduce_kernel-L_pc2
    s_addc_u32 s55, s55, 0
    v_and_b32 v192, 15, v255
    v_lshlrev_b32 v192, 7, v192
    global_load_dword v193, v192, s[54:55]
    s_waitcnt lgkmcnt(5)
    v_mfma_f32_16x16x32_bf16 v[120:123], a[136:139], a[48:51], 0
    ds_read_b128 a[72:75], v210 offset:0
    s_waitcnt lgkmcnt(5)
    v_mfma_f32_16x16x32_bf16 v[128:131], a[136:139], a[52:55], 0
    v_cvt_pk_bf16_f32 v72, v72, v73
    v_cvt_pk_bf16_f32 v73, v74, v75
    v_cvt_pk_bf16_f32 v74, v76, v77
    v_cvt_pk_bf16_f32 v75, v78, v79
    s_add_u32 s54, s39, 8192
    buffer_store_dwordx4 v[72:75], v216, s[28:31], s54 offen offset:1024 sc1
    s_waitcnt lgkmcnt(4)
    v_mfma_f32_16x16x32_bf16 v[136:139], a[136:139], a[56:59], 0
    ds_read_b128 a[76:79], v210 offset:8192
    s_waitcnt lgkmcnt(4)
    v_mfma_f32_16x16x32_bf16 v[144:147], a[136:139], a[60:63], 0
    s_waitcnt lgkmcnt(3)
    v_mfma_f32_16x16x32_bf16 v[152:155], a[136:139], a[64:67], 0
    ds_read_b128 a[80:83], v210 offset:16384
    s_waitcnt lgkmcnt(3)
    v_mfma_f32_16x16x32_bf16 v[160:163], a[136:139], a[68:71], 0
    v_cvt_pk_bf16_f32 v80, v80, v81
    v_cvt_pk_bf16_f32 v81, v82, v83
    v_cvt_pk_bf16_f32 v82, v84, v85
    v_cvt_pk_bf16_f32 v83, v86, v87
    s_add_u32 s54, s39, 8192
    buffer_store_dwordx4 v[80:83], v216, s[28:31], s54 offen offset:2048 sc1
    v_mfma_f32_16x16x32_bf16 v[124:127], a[140:143], a[48:51], 0
    ds_read_b128 a[84:87], v210 offset:24576
    v_mfma_f32_16x16x32_bf16 v[132:135], a[140:143], a[52:55], 0
    v_mfma_f32_16x16x32_bf16 v[140:143], a[140:143], a[56:59], 0
    ds_read_b128 a[88:91], v210 offset:32768
    v_mfma_f32_16x16x32_bf16 v[148:151], a[140:143], a[60:63], 0
    v_cvt_pk_bf16_f32 v88, v88, v89
    v_cvt_pk_bf16_f32 v89, v90, v91
    v_cvt_pk_bf16_f32 v90, v92, v93
    v_cvt_pk_bf16_f32 v91, v94, v95
    s_add_u32 s54, s39, 8192
    buffer_store_dwordx4 v[88:91], v216, s[28:31], s54 offen offset:3072 sc1
    v_mfma_f32_16x16x32_bf16 v[156:159], a[140:143], a[64:67], 0
    ds_read_b128 a[92:95], v210 offset:40960
    v_mfma_f32_16x16x32_bf16 v[164:167], a[140:143], a[68:71], 0
    s_waitcnt lgkmcnt(5)
    v_mfma_f32_16x16x32_bf16 v[120:123], a[152:155], a[72:75], v[120:123]
    ds_read_b128 a[48:51], v211 offset:0
    s_waitcnt lgkmcnt(5)
    v_mfma_f32_16x16x32_bf16 v[128:131], a[152:155], a[76:79], v[128:131]
    v_cvt_pk_bf16_f32 v96, v96, v97
    v_cvt_pk_bf16_f32 v97, v98, v99
    v_cvt_pk_bf16_f32 v98, v100, v101
    v_cvt_pk_bf16_f32 v99, v102, v103
    s_add_u32 s54, s39, 12288
    buffer_store_dwordx4 v[96:99], v216, s[28:31], s54 offen offset:0 sc1
    s_waitcnt lgkmcnt(4)
    v_mfma_f32_16x16x32_bf16 v[136:139], a[152:155], a[80:83], v[136:139]
    ds_read_b128 a[52:55], v211 offset:8192
    s_waitcnt lgkmcnt(4)
    v_mfma_f32_16x16x32_bf16 v[144:147], a[152:155], a[84:87], v[144:147]
    s_waitcnt lgkmcnt(3)
    v_mfma_f32_16x16x32_bf16 v[152:155], a[152:155], a[88:91], v[152:155]
    ds_read_b128 a[56:59], v211 offset:16384
    s_waitcnt lgkmcnt(3)
    v_mfma_f32_16x16x32_bf16 v[160:163], a[152:155], a[92:95], v[160:163]
    v_cvt_pk_bf16_f32 v104, v104, v105
    v_cvt_pk_bf16_f32 v105, v106, v107
    v_cvt_pk_bf16_f32 v106, v108, v109
    v_cvt_pk_bf16_f32 v107, v110, v111
    s_add_u32 s54, s39, 12288
    buffer_store_dwordx4 v[104:107], v216, s[28:31], s54 offen offset:1024 sc1
    v_mfma_f32_16x16x32_bf16 v[124:127], a[156:159], a[72:75], v[124:127]
    ds_read_b128 a[60:63], v211 offset:24576
    v_mfma_f32_16x16x32_bf16 v[132:135], a[156:159], a[76:79], v[132:135]
    v_mfma_f32_16x16x32_bf16 v[140:143], a[156:159], a[80:83], v[140:143]
    ds_read_b128 a[64:67], v211 offset:32768
    v_mfma_f32_16x16x32_bf16 v[148:151], a[156:159], a[84:87], v[148:151]
    v_cvt_pk_bf16_f32 v112, v112, v113
    v_cvt_pk_bf16_f32 v113, v114, v115
    v_cvt_pk_bf16_f32 v114, v116, v117
    v_cvt_pk_bf16_f32 v115, v118, v119
    s_add_u32 s54, s39, 12288
    buffer_store_dwordx4 v[112:115], v216, s[28:31], s54 offen offset:2048 sc1
    v_mfma_f32_16x16x32_bf16 v[156:159], a[156:159], a[88:91], v[156:159]
    ds_read_b128 a[68:71], v211 offset:40960
    v_mfma_f32_16x16x32_bf16 v[164:167], a[156:159], a[92:95], v[164:167]
    s_waitcnt lgkmcnt(5)
    v_mfma_f32_16x16x32_bf16 v[120:123], a[168:171], a[48:51], v[120:123]
    ds_read_b128 a[72:75], v212 offset:0
    s_waitcnt lgkmcnt(5)
    v_mfma_f32_16x16x32_bf16 v[128:131], a[168:171], a[52:55], v[128:131]
    s_waitcnt lgkmcnt(4)
    v_mfma_f32_16x16x32_bf16 v[136:139], a[168:171], a[56:59], v[136:139]
    ds_read_b128 a[76:79], v212 offset:8192
    s_waitcnt lgkmcnt(4)
    v_mfma_f32_16x16x32_bf16 v[144:147], a[168:171], a[60:63], v[144:147]
    s_waitcnt lgkmcnt(3)
    v_mfma_f32_16x16x32_bf16 v[152:155], a[168:171], a[64:67], v[152:155]
    ds_read_b128 a[80:83], v212 offset:16384
    s_waitcnt lgkmcnt(3)
    v_mfma_f32_16x16x32_bf16 v[160:163], a[168:171], a[68:71], v[160:163]
    v_mfma_f32_16x16x32_bf16 v[124:127], a[172:175], a[48:51], v[124:127]
    ds_read_b128 a[84:87], v212 offset:24576
    v_mfma_f32_16x16x32_bf16 v[132:135], a[172:175], a[52:55], v[132:135]
    v_mfma_f32_16x16x32_bf16 v[140:143], a[172:175], a[56:59], v[140:143]
    ds_read_b128 a[88:91], v212 offset:32768
    v_mfma_f32_16x16x32_bf16 v[148:151], a[172:175], a[60:63], v[148:151]
    v_mfma_f32_16x16x32_bf16 v[156:159], a[172:175], a[64:67], v[156:159]
    ds_read_b128 a[92:95], v212 offset:40960
    v_mfma_f32_16x16x32_bf16 v[164:167], a[172:175], a[68:71], v[164:167]
    s_waitcnt lgkmcnt(5)
    v_mfma_f32_16x16x32_bf16 v[120:123], a[184:187], a[72:75], v[120:123]
    v_xor_b32 v209, 0x100, v209
    s_waitcnt lgkmcnt(4)
    v_mfma_f32_16x16x32_bf16 v[128:131], a[184:187], a[76:79], v[128:131]
    v_xor_b32 v210, 0x100, v210
    s_waitcnt lgkmcnt(3)
    v_mfma_f32_16x16x32_bf16 v[136:139], a[184:187], a[80:83], v[136:139]
    v_xor_b32 v211, 0x100, v211
    s_waitcnt lgkmcnt(2)
    v_mfma_f32_16x16x32_bf16 v[144:147], a[184:187], a[84:87], v[144:147]
    v_xor_b32 v212, 0x100, v212
    s_waitcnt lgkmcnt(1)
    v_mfma_f32_16x16x32_bf16 v[152:155], a[184:187], a[88:91], v[152:155]
    ds_read_b128 a[48:51], v209 offset:0
    s_waitcnt lgkmcnt(1)
    v_mfma_f32_16x16x32_bf16 v[160:163], a[184:187], a[92:95], v[160:163]
    v_mfma_f32_16x16x32_bf16 v[124:127], a[188:191], a[72:75], v[124:127]
    ds_read_b128 a[52:55], v209 offset:8192
    v_mfma_f32_16x16x32_bf16 v[132:135], a[188:191], a[76:79], v[132:135]
    ds_read_b128 a[56:59], v209 offset:16384
    v_mfma_f32_16x16x32_bf16 v[140:143], a[188:191], a[80:83], v[140:143]
    ds_read_b128 a[60:63], v209 offset:24576
    v_mfma_f32_16x16x32_bf16 v[148:151], a[188:191], a[84:87], v[148:151]
    ds_read_b128 a[64:67], v209 offset:32768
    v_mfma_f32_16x16x32_bf16 v[156:159], a[188:191], a[88:91], v[156:159]
    ds_read_b128 a[68:71], v209 offset:40960
    v_mfma_f32_16x16x32_bf16 v[164:167], a[188:191], a[92:95], v[164:167]
    s_waitcnt lgkmcnt(5)
    v_mfma_f32_16x16x32_bf16 v[120:123], a[200:203], a[48:51], v[120:123]
    ds_read_b128 a[72:75], v210 offset:0
    s_waitcnt lgkmcnt(5)
    v_mfma_f32_16x16x32_bf16 v[128:131], a[200:203], a[52:55], v[128:131]
    s_waitcnt lgkmcnt(4)
    v_mfma_f32_16x16x32_bf16 v[136:139], a[200:203], a[56:59], v[136:139]
    ds_read_b128 a[76:79], v210 offset:8192
    s_waitcnt lgkmcnt(4)
    v_mfma_f32_16x16x32_bf16 v[144:147], a[200:203], a[60:63], v[144:147]
    s_waitcnt lgkmcnt(3)
    v_mfma_f32_16x16x32_bf16 v[152:155], a[200:203], a[64:67], v[152:155]
    ds_read_b128 a[80:83], v210 offset:16384
    s_waitcnt lgkmcnt(3)
    v_mfma_f32_16x16x32_bf16 v[160:163], a[200:203], a[68:71], v[160:163]
    v_mfma_f32_16x16x32_bf16 v[124:127], a[204:207], a[48:51], v[124:127]
    ds_read_b128 a[84:87], v210 offset:24576
    v_mfma_f32_16x16x32_bf16 v[132:135], a[204:207], a[52:55], v[132:135]
    v_mfma_f32_16x16x32_bf16 v[140:143], a[204:207], a[56:59], v[140:143]
    ds_read_b128 a[88:91], v210 offset:32768
    v_mfma_f32_16x16x32_bf16 v[148:151], a[204:207], a[60:63], v[148:151]
    v_mfma_f32_16x16x32_bf16 v[156:159], a[204:207], a[64:67], v[156:159]
    ds_read_b128 a[92:95], v210 offset:40960
    v_mfma_f32_16x16x32_bf16 v[164:167], a[204:207], a[68:71], v[164:167]
    s_waitcnt lgkmcnt(5)
    v_mfma_f32_16x16x32_bf16 v[120:123], a[216:219], a[72:75], v[120:123]
    ds_read_b128 a[48:51], v211 offset:0
    s_waitcnt lgkmcnt(5)
    v_mfma_f32_16x16x32_bf16 v[128:131], a[216:219], a[76:79], v[128:131]
    s_waitcnt lgkmcnt(4)
    v_mfma_f32_16x16x32_bf16 v[136:139], a[216:219], a[80:83], v[136:139]
    ds_read_b128 a[52:55], v211 offset:8192
    s_waitcnt lgkmcnt(4)
    v_mfma_f32_16x16x32_bf16 v[144:147], a[216:219], a[84:87], v[144:147]
    s_waitcnt lgkmcnt(3)
    v_mfma_f32_16x16x32_bf16 v[152:155], a[216:219], a[88:91], v[152:155]
    ds_read_b128 a[56:59], v211 offset:16384
    s_waitcnt lgkmcnt(3)
    v_mfma_f32_16x16x32_bf16 v[160:163], a[216:219], a[92:95], v[160:163]
    v_mfma_f32_16x16x32_bf16 v[124:127], a[220:223], a[72:75], v[124:127]
    ds_read_b128 a[60:63], v211 offset:24576
    v_mfma_f32_16x16x32_bf16 v[132:135], a[220:223], a[76:79], v[132:135]
    v_mfma_f32_16x16x32_bf16 v[140:143], a[220:223], a[80:83], v[140:143]
    ds_read_b128 a[64:67], v211 offset:32768
    v_mfma_f32_16x16x32_bf16 v[148:151], a[220:223], a[84:87], v[148:151]
    v_mfma_f32_16x16x32_bf16 v[156:159], a[220:223], a[88:91], v[156:159]
    ds_read_b128 a[68:71], v211 offset:40960
    v_mfma_f32_16x16x32_bf16 v[164:167], a[220:223], a[92:95], v[164:167]
    s_waitcnt lgkmcnt(5)
    v_mfma_f32_16x16x32_bf16 v[120:123], a[232:235], a[48:51], v[120:123]
    ds_read_b128 a[72:75], v212 offset:0
    s_waitcnt lgkmcnt(5)
    v_mfma_f32_16x16x32_bf16 v[128:131], a[232:235], a[52:55], v[128:131]
    s_waitcnt lgkmcnt(4)
    v_mfma_f32_16x16x32_bf16 v[136:139], a[232:235], a[56:59], v[136:139]
    ds_read_b128 a[76:79], v212 offset:8192
    s_waitcnt lgkmcnt(4)
    v_mfma_f32_16x16x32_bf16 v[144:147], a[232:235], a[60:63], v[144:147]
    s_waitcnt lgkmcnt(3)
    v_mfma_f32_16x16x32_bf16 v[152:155], a[232:235], a[64:67], v[152:155]
    ds_read_b128 a[80:83], v212 offset:16384
    s_waitcnt lgkmcnt(3)
    v_mfma_f32_16x16x32_bf16 v[160:163], a[232:235], a[68:71], v[160:163]
    v_mfma_f32_16x16x32_bf16 v[124:127], a[236:239], a[48:51], v[124:127]
    ds_read_b128 a[84:87], v212 offset:24576
    v_mfma_f32_16x16x32_bf16 v[132:135], a[236:239], a[52:55], v[132:135]
    v_mfma_f32_16x16x32_bf16 v[140:143], a[236:239], a[56:59], v[140:143]
    ds_read_b128 a[88:91], v212 offset:32768
    v_mfma_f32_16x16x32_bf16 v[148:151], a[236:239], a[60:63], v[148:151]
    v_mfma_f32_16x16x32_bf16 v[156:159], a[236:239], a[64:67], v[156:159]
    ds_read_b128 a[92:95], v212 offset:40960
    v_mfma_f32_16x16x32_bf16 v[164:167], a[236:239], a[68:71], v[164:167]
    s_waitcnt lgkmcnt(5)
    v_mfma_f32_16x16x32_bf16 v[120:123], a[248:251], a[72:75], v[120:123]
    s_waitcnt lgkmcnt(4)
    v_mfma_f32_16x16x32_bf16 v[128:131], a[248:251], a[76:79], v[128:131]
    s_waitcnt lgkmcnt(3)
    v_mfma_f32_16x16x32_bf16 v[136:139], a[248:251], a[80:83], v[136:139]
    s_waitcnt lgkmcnt(2)
    v_mfma_f32_16x16x32_bf16 v[144:147], a[248:251], a[84:87], v[144:147]
    s_waitcnt lgkmcnt(1)
    v_mfma_f32_16x16x32_bf16 v[152:155], a[248:251], a[88:91], v[152:155]
    s_waitcnt lgkmcnt(0)
    v_mfma_f32_16x16x32_bf16 v[160:163], a[248:251], a[92:95], v[160:163]
    v_mfma_f32_16x16x32_bf16 v[124:127], a[252:255], a[72:75], v[124:127]
    v_mfma_f32_16x16x32_bf16 v[132:135], a[252:255], a[76:79], v[132:135]
    v_mfma_f32_16x16x32_bf16 v[140:143], a[252:255], a[80:83], v[140:143]
    v_mfma_f32_16x16x32_bf16 v[148:151], a[252:255], a[84:87], v[148:151]
    v_mfma_f32_16x16x32_bf16 v[156:159], a[252:255], a[88:91], v[156:159]
    v_mfma_f32_16x16x32_bf16 v[164:167], a[252:255], a[92:95], v[164:167]
    v_cvt_pk_bf16_f32 v120, v120, v121
    v_cvt_pk_bf16_f32 v121, v122, v123
    s_nop 0
    v_cvt_pk_bf16_f32 v122, v124, v125
    v_cvt_pk_bf16_f32 v123, v126, v127
    s_add_u32 s54, s39, 12288
    buffer_store_dwordx4 v[120:123], v216, s[28:31], s54 offen offset:3072 sc1
    v_cvt_pk_bf16_f32 v128, v128, v129
    v_cvt_pk_bf16_f32 v129, v130, v131
    v_cvt_pk_bf16_f32 v130, v132, v133
    v_cvt_pk_bf16_f32 v131, v134, v135
    s_add_u32 s54, s39, 16384
    buffer_store_dwordx4 v[128:131], v216, s[28:31], s54 offen offset:0 sc1
    v_cvt_pk_bf16_f32 v136, v136, v137
    v_cvt_pk_bf16_f32 v137, v138, v139
    v_cvt_pk_bf16_f32 v138, v140, v141
    v_cvt_pk_bf16_f32 v139, v142, v143
    s_add_u32 s54, s39, 16384
    buffer_store_dwordx4 v[136:139], v216, s[28:31], s54 offen offset:1024 sc1
    v_cvt_pk_bf16_f32 v144, v144, v145
    v_cvt_pk_bf16_f32 v145, v146, v147
    v_cvt_pk_bf16_f32 v146, v148, v149
    v_cvt_pk_bf16_f32 v147, v150, v151
    s_add_u32 s54, s39, 16384
    buffer_store_dwordx4 v[144:147], v216, s[28:31], s54 offen offset:2048 sc1
    v_cvt_pk_bf16_f32 v152, v152, v153
    v_cvt_pk_bf16_f32 v153, v154, v155
    v_cvt_pk_bf16_f32 v154, v156, v157
    v_cvt_pk_bf16_f32 v155, v158, v159
    s_add_u32 s54, s39, 16384
    buffer_store_dwordx4 v[152:155], v216, s[28:31], s54 offen offset:3072 sc1
    v_cvt_pk_bf16_f32 v160, v160, v161
    v_cvt_pk_bf16_f32 v161, v162, v163
    v_cvt_pk_bf16_f32 v162, v164, v165
    v_cvt_pk_bf16_f32 v163, v166, v167
    s_add_u32 s54, s39, 20480
    buffer_store_dwordx4 v[160:163], v216, s[28:31], s54 offen offset:0 sc1
L_k1_end:
    s_endpgm
L_rescale:
    v_max_f32 v250, 0, v250
    v_ceil_f32 v250, v250
    v_add_f32 v241, v241, v250
    v_cvt_i32_f32 v250, v250
    v_sub_u32 v250, 0, v250
    v_ldexp_f32 v244, v244, v250
    v_ldexp_f32 v245, v245, v250
    v_max_f32 v251, 0, v251
    v_ceil_f32 v251, v251
    v_add_f32 v242, v242, v251
    v_cvt_i32_f32 v251, v251
    v_sub_u32 v251, 0, v251
    v_ldexp_f32 v246, v246, v251
    v_ldexp_f32 v247, v247, v251
    v_max_f32 v252, 0, v252
    v_ceil_f32 v252, v252
    v_add_f32 v243, v243, v252
    v_cvt_i32_f32 v252, v252
    v_sub_u32 v252, 0, v252
    v_ldexp_f32 v248, v248, v252
    v_ldexp_f32 v249, v249, v252
    v_lshlrev_b32 v4, 16, v0
    v_and_b32 v5, 0xffff0000, v0
    v_ldexp_f32 v4, v4, v250
    v_ldexp_f32 v5, v5, v250
    v_cvt_pk_bf16_f32 v0, v4, v5
    v_lshlrev_b32 v4, 16, v1
    v_and_b32 v5, 0xffff0000, v1
    v_ldexp_f32 v4, v4, v250
    v_ldexp_f32 v5, v5, v250
    v_cvt_pk_bf16_f32 v1, v4, v5
    v_lshlrev_b32 v4, 16, v2
    v_and_b32 v5, 0xffff0000, v2
    v_ldexp_f32 v4, v4, v250
    v_ldexp_f32 v5, v5, v250
    v_cvt_pk_bf16_f32 v2, v4, v5
    v_lshlrev_b32 v4, 16, v3
    v_and_b32 v5, 0xffff0000, v3
    v_ldexp_f32 v4, v4, v250
    v_ldexp_f32 v5, v5, v250
    v_cvt_pk_bf16_f32 v3, v4, v5
    ds_write_b128 v226, v[0:3] offset:0
    v_lshlrev_b32 v12, 16, v8
    v_and_b32 v13, 0xffff0000, v8
    v_ldexp_f32 v12, v12, v250
    v_ldexp_f32 v13, v13, v250
    v_cvt_pk_bf16_f32 v8, v12, v13
    v_lshlrev_b32 v12, 16, v9
    v_and_b32 v13, 0xffff0000, v9
    v_ldexp_f32 v12, v12, v250
    v_ldexp_f32 v13, v13, v250
    v_cvt_pk_bf16_f32 v9, v12, v13
    v_lshlrev_b32 v12, 16, v10
    v_and_b32 v13, 0xffff0000, v10
    v_ldexp_f32 v12, v12, v250
    v_ldexp_f32 v13, v13, v250
    v_cvt_pk_bf16_f32 v10, v12, v13
    v_lshlrev_b32 v12, 16, v11
    v_and_b32 v13, 0xffff0000, v11
    v_ldexp_f32 v12, v12, v250
    v_ldexp_f32 v13, v13, v250
    v_cvt_pk_bf16_f32 v11, v12, v13
    ds_write_b128 v227, v[8:11] offset:0
    v_lshlrev_b32 v20, 16, v16
    v_and_b32 v21, 0xffff0000, v16
    v_ldexp_f32 v20, v20, v251
    v_ldexp_f32 v21, v21, v251
    v_cvt_pk_bf16_f32 v16, v20, v21
    v_lshlrev_b32 v20, 16, v17
    v_and_b32 v21, 0xffff0000, v17
    v_ldexp_f32 v20, v20, v251
    v_ldexp_f32 v21, v21, v251
    v_cvt_pk_bf16_f32 v17, v20, v21
    v_lshlrev_b32 v20, 16, v18
    v_and_b32 v21, 0xffff0000, v18
    v_ldexp_f32 v20, v20, v251
    v_ldexp_f32 v21, v21, v251
    v_cvt_pk_bf16_f32 v18, v20, v21
    v_lshlrev_b32 v20, 16, v19
    v_and_b32 v21, 0xffff0000, v19
    v_ldexp_f32 v20, v20, v251
    v_ldexp_f32 v21, v21, v251
    v_cvt_pk_bf16_f32 v19, v20, v21
    ds_write_b128 v226, v[16:19] offset:8192
    v_lshlrev_b32 v28, 16, v24
    v_and_b32 v29, 0xffff0000, v24
    v_ldexp_f32 v28, v28, v251
    v_ldexp_f32 v29, v29, v251
    v_cvt_pk_bf16_f32 v24, v28, v29
    v_lshlrev_b32 v28, 16, v25
    v_and_b32 v29, 0xffff0000, v25
    v_ldexp_f32 v28, v28, v251
    v_ldexp_f32 v29, v29, v251
    v_cvt_pk_bf16_f32 v25, v28, v29
    v_lshlrev_b32 v28, 16, v26
    v_and_b32 v29, 0xffff0000, v26
    v_ldexp_f32 v28, v28, v251
    v_ldexp_f32 v29, v29, v251
    v_cvt_pk_bf16_f32 v26, v28, v29
    v_lshlrev_b32 v28, 16, v27
    v_and_b32 v29, 0xffff0000, v27
    v_ldexp_f32 v28, v28, v251
    v_ldexp_f32 v29, v29, v251
    v_cvt_pk_bf16_f32 v27, v28, v29
    ds_write_b128 v227, v[24:27] offset:8192
    v_lshlrev_b32 v36, 16, v32
    v_and_b32 v37, 0xffff0000, v32
    v_ldexp_f32 v36, v36, v252
    v_ldexp_f32 v37, v37, v252
    v_cvt_pk_bf16_f32 v32, v36, v37
    v_lshlrev_b32 v36, 16, v33
    v_and_b32 v37, 0xffff0000, v33
    v_ldexp_f32 v36, v36, v252
    v_ldexp_f32 v37, v37, v252
    v_cvt_pk_bf16_f32 v33, v36, v37
    v_lshlrev_b32 v36, 16, v34
    v_and_b32 v37, 0xffff0000, v34
    v_ldexp_f32 v36, v36, v252
    v_ldexp_f32 v37, v37, v252
    v_cvt_pk_bf16_f32 v34, v36, v37
    v_lshlrev_b32 v36, 16, v35
    v_and_b32 v37, 0xffff0000, v35
    v_ldexp_f32 v36, v36, v252
    v_ldexp_f32 v37, v37, v252
    v_cvt_pk_bf16_f32 v35, v36, v37
    ds_write_b128 v226, v[32:35] offset:16384
    v_lshlrev_b32 v44, 16, v40
    v_and_b32 v45, 0xffff0000, v40
    v_ldexp_f32 v44, v44, v252
    v_ldexp_f32 v45, v45, v252
    v_cvt_pk_bf16_f32 v40, v44, v45
    v_lshlrev_b32 v44, 16, v41
    v_and_b32 v45, 0xffff0000, v41
    v_ldexp_f32 v44, v44, v252
    v_ldexp_f32 v45, v45, v252
    v_cvt_pk_bf16_f32 v41, v44, v45
    v_lshlrev_b32 v44, 16, v42
    v_and_b32 v45, 0xffff0000, v42
    v_ldexp_f32 v44, v44, v252
    v_ldexp_f32 v45, v45, v252
    v_cvt_pk_bf16_f32 v42, v44, v45
    v_lshlrev_b32 v44, 16, v43
    v_and_b32 v45, 0xffff0000, v43
    v_ldexp_f32 v44, v44, v252
    v_ldexp_f32 v45, v45, v252
    v_cvt_pk_bf16_f32 v43, v44, v45
    ds_write_b128 v227, v[40:43] offset:16384
    v_lshlrev_b32 v52, 16, v48
    v_and_b32 v53, 0xffff0000, v48
    v_ldexp_f32 v52, v52, v250
    v_ldexp_f32 v53, v53, v250
    v_cvt_pk_bf16_f32 v48, v52, v53
    v_lshlrev_b32 v52, 16, v49
    v_and_b32 v53, 0xffff0000, v49
    v_ldexp_f32 v52, v52, v250
    v_ldexp_f32 v53, v53, v250
    v_cvt_pk_bf16_f32 v49, v52, v53
    v_lshlrev_b32 v52, 16, v50
    v_and_b32 v53, 0xffff0000, v50
    v_ldexp_f32 v52, v52, v250
    v_ldexp_f32 v53, v53, v250
    v_cvt_pk_bf16_f32 v50, v52, v53
    v_lshlrev_b32 v52, 16, v51
    v_and_b32 v53, 0xffff0000, v51
    v_ldexp_f32 v52, v52, v250
    v_ldexp_f32 v53, v53, v250
    v_cvt_pk_bf16_f32 v51, v52, v53
    v_lshlrev_b32 v60, 16, v56
    v_and_b32 v61, 0xffff0000, v56
    v_ldexp_f32 v60, v60, v250
    v_ldexp_f32 v61, v61, v250
    v_cvt_pk_bf16_f32 v56, v60, v61
    v_lshlrev_b32 v60, 16, v57
    v_and_b32 v61, 0xffff0000, v57
    v_ldexp_f32 v60, v60, v250
    v_ldexp_f32 v61, v61, v250
    v_cvt_pk_bf16_f32 v57, v60, v61
    v_lshlrev_b32 v60, 16, v58
    v_and_b32 v61, 0xffff0000, v58
    v_ldexp_f32 v60, v60, v250
    v_ldexp_f32 v61, v61, v250
    v_cvt_pk_bf16_f32 v58, v60, v61
    v_lshlrev_b32 v60, 16, v59
    v_and_b32 v61, 0xffff0000, v59
    v_ldexp_f32 v60, v60, v250
    v_ldexp_f32 v61, v61, v250
    v_cvt_pk_bf16_f32 v59, v60, v61
    v_lshlrev_b32 v68, 16, v64
    v_and_b32 v69, 0xffff0000, v64
    v_ldexp_f32 v68, v68, v251
    v_ldexp_f32 v69, v69, v251
    v_cvt_pk_bf16_f32 v64, v68, v69
    v_lshlrev_b32 v68, 16, v65
    v_and_b32 v69, 0xffff0000, v65
    v_ldexp_f32 v68, v68, v251
    v_ldexp_f32 v69, v69, v251
    v_cvt_pk_bf16_f32 v65, v68, v69
    v_lshlrev_b32 v68, 16, v66
    v_and_b32 v69, 0xffff0000, v66
    v_ldexp_f32 v68, v68, v251
    v_ldexp_f32 v69, v69, v251
    v_cvt_pk_bf16_f32 v66, v68, v69
    v_lshlrev_b32 v68, 16, v67
    v_and_b32 v69, 0xffff0000, v67
    v_ldexp_f32 v68, v68, v251
    v_ldexp_f32 v69, v69, v251
    v_cvt_pk_bf16_f32 v67, v68, v69
    v_lshlrev_b32 v76, 16, v72
    v_and_b32 v77, 0xffff0000, v72
    v_ldexp_f32 v76, v76, v251
    v_ldexp_f32 v77, v77, v251
    v_cvt_pk_bf16_f32 v72, v76, v77
    v_lshlrev_b32 v76, 16, v73
    v_and_b32 v77, 0xffff0000, v73
    v_ldexp_f32 v76, v76, v251
    v_ldexp_f32 v77, v77, v251
    v_cvt_pk_bf16_f32 v73, v76, v77
    v_lshlrev_b32 v76, 16, v74
    v_and_b32 v77, 0xffff0000, v74
    v_ldexp_f32 v76, v76, v251
    v_ldexp_f32 v77, v77, v251
    v_cvt_pk_bf16_f32 v74, v76, v77
    v_lshlrev_b32 v76, 16, v75
    v_and_b32 v77, 0xffff0000, v75
    v_ldexp_f32 v76, v76, v251
    v_ldexp_f32 v77, v77, v251
    v_cvt_pk_bf16_f32 v75, v76, v77
    v_lshlrev_b32 v84, 16, v80
    v_and_b32 v85, 0xffff0000, v80
    v_ldexp_f32 v84, v84, v252
    v_ldexp_f32 v85, v85, v252
    v_cvt_pk_bf16_f32 v80, v84, v85
    v_lshlrev_b32 v84, 16, v81
    v_and_b32 v85, 0xffff0000, v81
    v_ldexp_f32 v84, v84, v252
    v_ldexp_f32 v85, v85, v252
    v_cvt_pk_bf16_f32 v81, v84, v85
    v_lshlrev_b32 v84, 16, v82
    v_and_b32 v85, 0xffff0000, v82
    v_ldexp_f32 v84, v84, v252
    v_ldexp_f32 v85, v85, v252
    v_cvt_pk_bf16_f32 v82, v84, v85
    v_lshlrev_b32 v84, 16, v83
    v_and_b32 v85, 0xffff0000, v83
    v_ldexp_f32 v84, v84, v252
    v_ldexp_f32 v85, v85, v252
    v_cvt_pk_bf16_f32 v83, v84, v85
    v_lshlrev_b32 v92, 16, v88
    v_and_b32 v93, 0xffff0000, v88
    v_ldexp_f32 v92, v92, v252
    v_ldexp_f32 v93, v93, v252
    v_cvt_pk_bf16_f32 v88, v92, v93
    v_lshlrev_b32 v92, 16, v89
    v_and_b32 v93, 0xffff0000, v89
    v_ldexp_f32 v92, v92, v252
    v_ldexp_f32 v93, v93, v252
    v_cvt_pk_bf16_f32 v89, v92, v93
    v_lshlrev_b32 v92, 16, v90
    v_and_b32 v93, 0xffff0000, v90
    v_ldexp_f32 v92, v92, v252
    v_ldexp_f32 v93, v93, v252
    v_cvt_pk_bf16_f32 v90, v92, v93
    v_lshlrev_b32 v92, 16, v91
    v_and_b32 v93, 0xffff0000, v91
    v_ldexp_f32 v92, v92, v252
    v_ldexp_f32 v93, v93, v252
    v_cvt_pk_bf16_f32 v91, v92, v93
    s_waitcnt lgkmcnt(0)
    s_barrier
    s_branch L_rescale_done
.globl gqa_reduce_kernel
.p2align 8
.type gqa_reduce_kernel,@function
gqa_reduce_kernel:
    s_cmp_ge_u32 s2, 1344
    s_cbranch_scc1 L_k2_end
    s_load_dwordx2 s[4:5], s[0:1], 56
    s_load_dwordx2 s[6:7], s[0:1], 40
    v_and_b32 v2, 63, v0
    s_mov_b32 s16, s2
    v_lshlrev_b32 v5, 4, v2
    s_mul_hi_u32 s17, s16, 51130564
    s_mul_i32 s18, s17, 84
    s_sub_u32 s18, s16, s18
    s_mul_i32 s21, s17, 1376256
    s_lshl_b32 s22, s18, 10
    s_waitcnt lgkmcnt(0)
    s_add_u32 s8, s4, s21
    s_addc_u32 s9, s5, 0
    s_and_b32 s9, s9, 0xffff
    s_mov_b32 s10, 1376256
    s_mov_b32 s11, 0x20000
    buffer_load_dwordx4 v[16:19], v5, s[8:11], s22 offen
    s_add_u32 s22, s22, 86016
    buffer_load_dwordx4 v[20:23], v5, s[8:11], s22 offen
    s_add_u32 s22, s22, 86016
    buffer_load_dwordx4 v[24:27], v5, s[8:11], s22 offen
    s_add_u32 s22, s22, 86016
    buffer_load_dwordx4 v[28:31], v5, s[8:11], s22 offen
    s_add_u32 s22, s22, 86016
    buffer_load_dwordx4 v[32:35], v5, s[8:11], s22 offen
    s_add_u32 s22, s22, 86016
    buffer_load_dwordx4 v[36:39], v5, s[8:11], s22 offen
    s_add_u32 s22, s22, 86016
    buffer_load_dwordx4 v[40:43], v5, s[8:11], s22 offen
    s_add_u32 s22, s22, 86016
    buffer_load_dwordx4 v[44:47], v5, s[8:11], s22 offen
    s_add_u32 s22, s22, 86016
    buffer_load_dwordx4 v[48:51], v5, s[8:11], s22 offen
    s_add_u32 s22, s22, 86016
    buffer_load_dwordx4 v[52:55], v5, s[8:11], s22 offen
    s_add_u32 s22, s22, 86016
    buffer_load_dwordx4 v[56:59], v5, s[8:11], s22 offen
    s_add_u32 s22, s22, 86016
    buffer_load_dwordx4 v[60:63], v5, s[8:11], s22 offen
    s_add_u32 s22, s22, 86016
    buffer_load_dwordx4 v[64:67], v5, s[8:11], s22 offen
    s_add_u32 s22, s22, 86016
    buffer_load_dwordx4 v[68:71], v5, s[8:11], s22 offen
    s_add_u32 s22, s22, 86016
    buffer_load_dwordx4 v[72:75], v5, s[8:11], s22 offen
    s_add_u32 s22, s22, 86016
    buffer_load_dwordx4 v[76:79], v5, s[8:11], s22 offen
    s_mul_i32 s19, s18, 3121
    s_lshr_b32 s19, s19, 16
    s_mul_i32 s20, s19, 21
    s_sub_u32 s20, s18, s20
    s_mov_b32 s12, s6
    s_and_b32 s13, s7, 0xffff
    s_mov_b32 s14, 1376256
    s_mov_b32 s15, 0x20000
    v_and_b32 v3, 15, v2
    v_mul_u32_u24 v3, 896, v3
    v_lshrrev_b32 v4, 4, v2
    v_lshlrev_b32 v4, 3, v4
    v_add_u32 v3, v3, v4
    s_mov_b32 s33, 0
    s_mov_b32 s34, 3
    s_mov_b32 s35, 86
    s_mov_b32 s36, 0
    s_cmp_ge_u32 s20, 9
    s_cselect_b32 s33, 9, s33
    s_cselect_b32 s34, 2, s34
    s_cselect_b32 s35, 128, s35
    s_cselect_b32 s36, 3, s36
    s_cmp_ge_u32 s20, 15
    s_cselect_b32 s33, 15, s33
    s_cselect_b32 s34, 2, s34
    s_cselect_b32 s35, 128, s35
    s_cselect_b32 s36, 5, s36
    s_sub_u32 s28, s20, s33
    s_lshl_b32 s28, s28, 1
    s_add_u32 s28, s28, 0
    s_mul_i32 s24, s28, s35
    s_lshr_b32 s24, s24, 8
    s_mul_i32 s25, s24, s34
    s_sub_u32 s25, s28, s25
    s_add_u32 s25, s25, s36
    s_mul_i32 s26, s17, 96
    s_lshl_b32 s24, s24, 4
    s_add_u32 s26, s26, s24
    s_mul_i32 s26, s26, 896
    s_mul_i32 s27, s19, 224
    s_lshl_b32 s25, s25, 5
    s_add_u32 s27, s27, s25
    s_add_u32 s30, s26, s27
    s_sub_u32 s28, s20, s33
    s_lshl_b32 s28, s28, 1
    s_add_u32 s28, s28, 1
    s_mul_i32 s24, s28, s35
    s_lshr_b32 s24, s24, 8
    s_mul_i32 s25, s24, s34
    s_sub_u32 s25, s28, s25
    s_add_u32 s25, s25, s36
    s_mul_i32 s26, s17, 96
    s_lshl_b32 s24, s24, 4
    s_add_u32 s26, s26, s24
    s_mul_i32 s26, s26, 896
    s_mul_i32 s27, s19, 224
    s_lshl_b32 s25, s25, 5
    s_add_u32 s27, s27, s25
    s_add_u32 s31, s26, s27
    s_waitcnt vmcnt(15)
    v_lshlrev_b32 v8, 16, v16
    v_and_b32 v9, 0xffff0000, v16
    v_lshlrev_b32 v10, 16, v17
    v_and_b32 v11, 0xffff0000, v17
    v_lshlrev_b32 v12, 16, v18
    v_and_b32 v13, 0xffff0000, v18
    v_lshlrev_b32 v14, 16, v19
    v_and_b32 v15, 0xffff0000, v19
    s_waitcnt vmcnt(14)
    v_lshlrev_b32 v6, 16, v20
    v_and_b32 v7, 0xffff0000, v20
    v_add_f32 v8, v8, v6
    v_add_f32 v9, v9, v7
    v_lshlrev_b32 v6, 16, v21
    v_and_b32 v7, 0xffff0000, v21
    v_add_f32 v10, v10, v6
    v_add_f32 v11, v11, v7
    v_lshlrev_b32 v6, 16, v22
    v_and_b32 v7, 0xffff0000, v22
    v_add_f32 v12, v12, v6
    v_add_f32 v13, v13, v7
    v_lshlrev_b32 v6, 16, v23
    v_and_b32 v7, 0xffff0000, v23
    v_add_f32 v14, v14, v6
    v_add_f32 v15, v15, v7
    s_waitcnt vmcnt(13)
    v_lshlrev_b32 v6, 16, v24
    v_and_b32 v7, 0xffff0000, v24
    v_add_f32 v8, v8, v6
    v_add_f32 v9, v9, v7
    v_lshlrev_b32 v6, 16, v25
    v_and_b32 v7, 0xffff0000, v25
    v_add_f32 v10, v10, v6
    v_add_f32 v11, v11, v7
    v_lshlrev_b32 v6, 16, v26
    v_and_b32 v7, 0xffff0000, v26
    v_add_f32 v12, v12, v6
    v_add_f32 v13, v13, v7
    v_lshlrev_b32 v6, 16, v27
    v_and_b32 v7, 0xffff0000, v27
    v_add_f32 v14, v14, v6
    v_add_f32 v15, v15, v7
    s_waitcnt vmcnt(12)
    v_lshlrev_b32 v6, 16, v28
    v_and_b32 v7, 0xffff0000, v28
    v_add_f32 v8, v8, v6
    v_add_f32 v9, v9, v7
    v_lshlrev_b32 v6, 16, v29
    v_and_b32 v7, 0xffff0000, v29
    v_add_f32 v10, v10, v6
    v_add_f32 v11, v11, v7
    v_lshlrev_b32 v6, 16, v30
    v_and_b32 v7, 0xffff0000, v30
    v_add_f32 v12, v12, v6
    v_add_f32 v13, v13, v7
    v_lshlrev_b32 v6, 16, v31
    v_and_b32 v7, 0xffff0000, v31
    v_add_f32 v14, v14, v6
    v_add_f32 v15, v15, v7
    s_waitcnt vmcnt(11)
    v_lshlrev_b32 v6, 16, v32
    v_and_b32 v7, 0xffff0000, v32
    v_add_f32 v8, v8, v6
    v_add_f32 v9, v9, v7
    v_lshlrev_b32 v6, 16, v33
    v_and_b32 v7, 0xffff0000, v33
    v_add_f32 v10, v10, v6
    v_add_f32 v11, v11, v7
    v_lshlrev_b32 v6, 16, v34
    v_and_b32 v7, 0xffff0000, v34
    v_add_f32 v12, v12, v6
    v_add_f32 v13, v13, v7
    v_lshlrev_b32 v6, 16, v35
    v_and_b32 v7, 0xffff0000, v35
    v_add_f32 v14, v14, v6
    v_add_f32 v15, v15, v7
    s_waitcnt vmcnt(10)
    v_lshlrev_b32 v6, 16, v36
    v_and_b32 v7, 0xffff0000, v36
    v_add_f32 v8, v8, v6
    v_add_f32 v9, v9, v7
    v_lshlrev_b32 v6, 16, v37
    v_and_b32 v7, 0xffff0000, v37
    v_add_f32 v10, v10, v6
    v_add_f32 v11, v11, v7
    v_lshlrev_b32 v6, 16, v38
    v_and_b32 v7, 0xffff0000, v38
    v_add_f32 v12, v12, v6
    v_add_f32 v13, v13, v7
    v_lshlrev_b32 v6, 16, v39
    v_and_b32 v7, 0xffff0000, v39
    v_add_f32 v14, v14, v6
    v_add_f32 v15, v15, v7
    s_waitcnt vmcnt(9)
    v_lshlrev_b32 v6, 16, v40
    v_and_b32 v7, 0xffff0000, v40
    v_add_f32 v8, v8, v6
    v_add_f32 v9, v9, v7
    v_lshlrev_b32 v6, 16, v41
    v_and_b32 v7, 0xffff0000, v41
    v_add_f32 v10, v10, v6
    v_add_f32 v11, v11, v7
    v_lshlrev_b32 v6, 16, v42
    v_and_b32 v7, 0xffff0000, v42
    v_add_f32 v12, v12, v6
    v_add_f32 v13, v13, v7
    v_lshlrev_b32 v6, 16, v43
    v_and_b32 v7, 0xffff0000, v43
    v_add_f32 v14, v14, v6
    v_add_f32 v15, v15, v7
    s_waitcnt vmcnt(8)
    v_lshlrev_b32 v6, 16, v44
    v_and_b32 v7, 0xffff0000, v44
    v_add_f32 v8, v8, v6
    v_add_f32 v9, v9, v7
    v_lshlrev_b32 v6, 16, v45
    v_and_b32 v7, 0xffff0000, v45
    v_add_f32 v10, v10, v6
    v_add_f32 v11, v11, v7
    v_lshlrev_b32 v6, 16, v46
    v_and_b32 v7, 0xffff0000, v46
    v_add_f32 v12, v12, v6
    v_add_f32 v13, v13, v7
    v_lshlrev_b32 v6, 16, v47
    v_and_b32 v7, 0xffff0000, v47
    v_add_f32 v14, v14, v6
    v_add_f32 v15, v15, v7
    s_waitcnt vmcnt(7)
    v_lshlrev_b32 v6, 16, v48
    v_and_b32 v7, 0xffff0000, v48
    v_add_f32 v8, v8, v6
    v_add_f32 v9, v9, v7
    v_lshlrev_b32 v6, 16, v49
    v_and_b32 v7, 0xffff0000, v49
    v_add_f32 v10, v10, v6
    v_add_f32 v11, v11, v7
    v_lshlrev_b32 v6, 16, v50
    v_and_b32 v7, 0xffff0000, v50
    v_add_f32 v12, v12, v6
    v_add_f32 v13, v13, v7
    v_lshlrev_b32 v6, 16, v51
    v_and_b32 v7, 0xffff0000, v51
    v_add_f32 v14, v14, v6
    v_add_f32 v15, v15, v7
    s_waitcnt vmcnt(6)
    v_lshlrev_b32 v6, 16, v52
    v_and_b32 v7, 0xffff0000, v52
    v_add_f32 v8, v8, v6
    v_add_f32 v9, v9, v7
    v_lshlrev_b32 v6, 16, v53
    v_and_b32 v7, 0xffff0000, v53
    v_add_f32 v10, v10, v6
    v_add_f32 v11, v11, v7
    v_lshlrev_b32 v6, 16, v54
    v_and_b32 v7, 0xffff0000, v54
    v_add_f32 v12, v12, v6
    v_add_f32 v13, v13, v7
    v_lshlrev_b32 v6, 16, v55
    v_and_b32 v7, 0xffff0000, v55
    v_add_f32 v14, v14, v6
    v_add_f32 v15, v15, v7
    s_waitcnt vmcnt(5)
    v_lshlrev_b32 v6, 16, v56
    v_and_b32 v7, 0xffff0000, v56
    v_add_f32 v8, v8, v6
    v_add_f32 v9, v9, v7
    v_lshlrev_b32 v6, 16, v57
    v_and_b32 v7, 0xffff0000, v57
    v_add_f32 v10, v10, v6
    v_add_f32 v11, v11, v7
    v_lshlrev_b32 v6, 16, v58
    v_and_b32 v7, 0xffff0000, v58
    v_add_f32 v12, v12, v6
    v_add_f32 v13, v13, v7
    v_lshlrev_b32 v6, 16, v59
    v_and_b32 v7, 0xffff0000, v59
    v_add_f32 v14, v14, v6
    v_add_f32 v15, v15, v7
    s_waitcnt vmcnt(4)
    v_lshlrev_b32 v6, 16, v60
    v_and_b32 v7, 0xffff0000, v60
    v_add_f32 v8, v8, v6
    v_add_f32 v9, v9, v7
    v_lshlrev_b32 v6, 16, v61
    v_and_b32 v7, 0xffff0000, v61
    v_add_f32 v10, v10, v6
    v_add_f32 v11, v11, v7
    v_lshlrev_b32 v6, 16, v62
    v_and_b32 v7, 0xffff0000, v62
    v_add_f32 v12, v12, v6
    v_add_f32 v13, v13, v7
    v_lshlrev_b32 v6, 16, v63
    v_and_b32 v7, 0xffff0000, v63
    v_add_f32 v14, v14, v6
    v_add_f32 v15, v15, v7
    s_waitcnt vmcnt(3)
    v_lshlrev_b32 v6, 16, v64
    v_and_b32 v7, 0xffff0000, v64
    v_add_f32 v8, v8, v6
    v_add_f32 v9, v9, v7
    v_lshlrev_b32 v6, 16, v65
    v_and_b32 v7, 0xffff0000, v65
    v_add_f32 v10, v10, v6
    v_add_f32 v11, v11, v7
    v_lshlrev_b32 v6, 16, v66
    v_and_b32 v7, 0xffff0000, v66
    v_add_f32 v12, v12, v6
    v_add_f32 v13, v13, v7
    v_lshlrev_b32 v6, 16, v67
    v_and_b32 v7, 0xffff0000, v67
    v_add_f32 v14, v14, v6
    v_add_f32 v15, v15, v7
    s_waitcnt vmcnt(2)
    v_lshlrev_b32 v6, 16, v68
    v_and_b32 v7, 0xffff0000, v68
    v_add_f32 v8, v8, v6
    v_add_f32 v9, v9, v7
    v_lshlrev_b32 v6, 16, v69
    v_and_b32 v7, 0xffff0000, v69
    v_add_f32 v10, v10, v6
    v_add_f32 v11, v11, v7
    v_lshlrev_b32 v6, 16, v70
    v_and_b32 v7, 0xffff0000, v70
    v_add_f32 v12, v12, v6
    v_add_f32 v13, v13, v7
    v_lshlrev_b32 v6, 16, v71
    v_and_b32 v7, 0xffff0000, v71
    v_add_f32 v14, v14, v6
    v_add_f32 v15, v15, v7
    s_waitcnt vmcnt(1)
    v_lshlrev_b32 v6, 16, v72
    v_and_b32 v7, 0xffff0000, v72
    v_add_f32 v8, v8, v6
    v_add_f32 v9, v9, v7
    v_lshlrev_b32 v6, 16, v73
    v_and_b32 v7, 0xffff0000, v73
    v_add_f32 v10, v10, v6
    v_add_f32 v11, v11, v7
    v_lshlrev_b32 v6, 16, v74
    v_and_b32 v7, 0xffff0000, v74
    v_add_f32 v12, v12, v6
    v_add_f32 v13, v13, v7
    v_lshlrev_b32 v6, 16, v75
    v_and_b32 v7, 0xffff0000, v75
    v_add_f32 v14, v14, v6
    v_add_f32 v15, v15, v7
    s_waitcnt vmcnt(0)
    v_lshlrev_b32 v6, 16, v76
    v_and_b32 v7, 0xffff0000, v76
    v_add_f32 v8, v8, v6
    v_add_f32 v9, v9, v7
    v_lshlrev_b32 v6, 16, v77
    v_and_b32 v7, 0xffff0000, v77
    v_add_f32 v10, v10, v6
    v_add_f32 v11, v11, v7
    v_lshlrev_b32 v6, 16, v78
    v_and_b32 v7, 0xffff0000, v78
    v_add_f32 v12, v12, v6
    v_add_f32 v13, v13, v7
    v_lshlrev_b32 v6, 16, v79
    v_and_b32 v7, 0xffff0000, v79
    v_add_f32 v14, v14, v6
    v_add_f32 v15, v15, v7
    v_cvt_pk_bf16_f32 v80, v8, v9
    v_cvt_pk_bf16_f32 v81, v10, v11
    v_cvt_pk_bf16_f32 v82, v12, v13
    v_cvt_pk_bf16_f32 v83, v14, v15
    buffer_store_dwordx2 v[80:81], v3, s[12:15], s30 offen
    buffer_store_dwordx2 v[82:83], v3, s[12:15], s31 offen
L_k2_end:
    s_endpgm
L_code_end:
.section .rodata,"a"
.p2align 6
.amdhsa_kernel standalone__gqa_block_cached__near_ridge_kernel
  .amdhsa_next_free_vgpr 512
  .amdhsa_next_free_sgpr 102
  .amdhsa_accum_offset 256
  .amdhsa_group_segment_fixed_size 0
  .amdhsa_kernarg_size 64
  .amdhsa_user_sgpr_count 2
  .amdhsa_user_sgpr_kernarg_segment_ptr 1
  .amdhsa_system_sgpr_workgroup_id_x 1
.end_amdhsa_kernel
.p2align 6
.amdhsa_kernel gqa_reduce_kernel
  .amdhsa_next_free_vgpr 96
  .amdhsa_next_free_sgpr 102
  .amdhsa_accum_offset 96
  .amdhsa_group_segment_fixed_size 0
  .amdhsa_kernarg_size 64
  .amdhsa_user_sgpr_count 2
  .amdhsa_user_sgpr_kernarg_segment_ptr 1
  .amdhsa_system_sgpr_workgroup_id_x 1
.end_amdhsa_kernel
```
